```python
import torch

def _softmax(x, axis=-1):
    return torch.softmax(x, dim=axis)
def _gelu(x):
    return torch.nn.functional.gelu(x, approximate="tanh")
def _silu(x):
    return torch.nn.functional.silu(x)
def _sigmoid(x):
    return torch.sigmoid(x)
def _layernorm(x, axis=-1, eps=1e-5):
    m = x.mean(dim=axis, keepdim=True)
    v = x.var(dim=axis, keepdim=True, unbiased=False)
    return (x - m) / torch.sqrt(v + eps)
def _scatter_add(tgt, idx, src, axis=0):
    return tgt.clone().index_add_(axis, idx, src)
def _segment_sum(src, seg, n):
    out = torch.zeros((n,) + src.shape[1:], dtype=src.dtype)
    return out.index_add_(0, seg, src)
def _pad(x, pw):
    flat = tuple(v for pair in reversed(pw) for v in pair)
    return torch.nn.functional.pad(x, flat)

kernel_name = 'sequential_preLN__softmax_full_mha__glu_gated_glu__prompt'

def setup_inputs():

    _w = (lambda a: (lambda t: t.to(torch.bfloat16) if t.is_floating_point() else t)(torch.as_tensor(a)))
    def _A_setup():
        B, S, D = 1, 2048, 1024
        return {
            "x": _w((lambda *s: torch.randn(*s, dtype=torch.bfloat16) * 0.05)(B, S, D)),
            "wqkv": _w((lambda *s: torch.randn(*s, dtype=torch.bfloat16) * 0.05)(D, 3 * D)),
            "wo": _w((lambda *s: torch.randn(*s, dtype=torch.bfloat16) * 0.05)(D, D)),
        }
    _A_in = _A_setup()

    def _B_setup():
        B, S, D, F = 1, 2048, 1024, 3584
        return {
            "x": _w((lambda *s: torch.randn(*s, dtype=torch.bfloat16) * 0.05)(B, S, D)),
            "w_gate": _w((lambda *s: torch.randn(*s, dtype=torch.bfloat16) * 0.05)(D, F)),
            "w_up": _w((lambda *s: torch.randn(*s, dtype=torch.bfloat16) * 0.05)(D, F)),
            "w_down": _w((lambda *s: torch.randn(*s, dtype=torch.bfloat16) * 0.05)(F, D)),
        }
    _B_in = _B_setup()

    return {
        "A_x": _A_in["x"],
        "A_wqkv": _A_in["wqkv"],
        "A_wo": _A_in["wo"],
        "B_x": _B_in["x"],
        "B_w_gate": _B_in["w_gate"],
        "B_w_up": _B_in["w_up"],
        "B_w_down": _B_in["w_down"],
    }

def reference(A_x, A_wqkv, A_wo, B_x, B_w_gate, B_w_up, B_w_down):
    def _A_ref(x, wqkv, wo):
        B, S, D = x.shape
        H = 32; Dh = D // H
        qkv = (lambda x, *d: x.permute(*d))((x @ wqkv).reshape(B, S, 3, H, Dh), 2, 0, 3, 1, 4)
        q, k, v = qkv[0], qkv[1], qkv[2]
        scale = Dh ** -0.5
        scores = torch.einsum("bhqd,bhkd->bhqk", q, k) * scale
        p = _softmax(scores, axis=-1)
        o = torch.einsum("bhqk,bhkd->bhqd", p, v)
        return (lambda x, *d: x.permute(*d))(o, 0, 2, 1, 3).reshape(B, S, D) @ wo

    def _B_ref(x, w_gate, w_up, w_down):
        g = torch.einsum("bsd,df->bsf", x, w_gate)
        u = torch.einsum("bsd,df->bsf", x, w_up)
        h = _sigmoid(g) * u
        return torch.einsum("bsf,fd->bsd", h, w_down)

    x = A_x
    h = x + _A_ref(_layernorm(x, axis=-1), A_wqkv, A_wo)
    h2 = h + _B_ref(_layernorm(h, axis=-1), B_w_gate, B_w_up, B_w_down)
    return h2
```

```asm
; @launch grid=(256,1,1) block=(256,1,1) lds=163840
.amdgcn_target "amdgcn-amd-amdhsa--gfx950"
.text
.globl sequential_preLN__softmax_full_mha__glu_gated_glu__prompt_kernel
.p2align 8
.type sequential_preLN__softmax_full_mha__glu_gated_glu__prompt_kernel,@function
sequential_preLN__softmax_full_mha__glu_gated_glu__prompt_kernel:
    s_cmp_ge_u32 s2, 256
    s_cbranch_scc1 sequential_preLN__softmax_full_mha__glu_gated_glu__prompt_kernel_end
    s_load_dwordx16 s[64:79], s[0:1], 0
    s_load_dwordx4 s[80:83], s[0:1], 64
    s_getpc_b64 s[4:5]
sequential_preLN__softmax_full_mha__glu_gated_glu__prompt_kernel_pc:
    s_and_b32 s5, s5, 0xffff
    s_mov_b32 s6, sequential_preLN__softmax_full_mha__glu_gated_glu__prompt_kernel_end - sequential_preLN__softmax_full_mha__glu_gated_glu__prompt_kernel_pc
    s_mov_b32 s7, 0x20000
    s_lshr_b32 s16, s2, 3
    s_and_b32 s16, s16, 15
    s_lshl_b32 s16, s16, 12
    v_lshlrev_b32 v7, 4, v0
    buffer_load_dwordx4 a[96:99], v7, s[4:7], s16 offen
    v_and_b32 v1, 63, v0
    v_lshrrev_b32 v2, 6, v0
    s_and_b32 s38, s2, 7
    v_readfirstlane_b32 s42, v2
    s_lshr_b32 s39, s2, 3
    v_lshrrev_b32 v2, 4, v1
    v_and_b32 v3, 15, v1
    s_and_b32 s40, s38, 1
    s_lshl_b32 s40, s40, 3
    s_and_b32 s45, s39, 7
    s_add_u32 s40, s40, s45
    s_lshr_b32 s41, s38, 1
    s_lshl_b32 s41, s41, 2
    s_lshr_b32 s45, s39, 3
    s_add_u32 s41, s41, s45
    s_lshr_b32 s43, s42, 1
    s_and_b32 s44, s42, 1
    v_lshlrev_b32 v4, 4, v1
    s_lshl_b32 s45, s40, 7
    s_lshl_b32 s46, s42, 5
    s_add_u32 s45, s45, s46
    s_lshl_b32 s16, s45, 11
    s_lshl_b32 s18, s42, 12
    v_lshrrev_b32 v20, 3, v1
    v_lshrrev_b32 v21, 4, v1
    v_and_b32 v22, 7, v1
    v_xor_b32 v21, v21, v22
    v_lshlrev_b32 v20, 11, v20
    v_lshl_add_u32 v14, v21, 4, v20
    v_add_u32 v14, s16, v14
    s_add_u32 s21, s40, s41
    s_and_b32 s94, s21, 3
    s_and_b32 s21, s21, 12
    s_lshl_b32 s16, s21, 7
    v_xor_b32 v15, 64, v14
    v_add_u32 v15, 15360, v15
    v_add_u32 v16, 30720, v14
    v_add_u32 v17, 30720, v15
    v_lshrrev_b32 v20, 1, v3
    v_xor_b32 v20, v20, v2
    v_lshlrev_b32 v20, 4, v20
    v_lshl_add_u32 v20, v3, 7, v20
    s_lshl_b32 s45, s43, 13
    v_add_u32 v208, s45, v20
    v_xor_b32 v209, 64, v208
    v_lshrrev_b32 v20, 3, v1
    v_and_b32 v21, 7, v1
    v_and_b32 v22, 2, v20
    v_xor_b32 v21, v21, v22
    v_lshlrev_b32 v21, 4, v21
    v_mul_u32_u24 v20, 6144, v20
    v_add_u32 v20, v20, v21
    s_mul_i32 s17, s42, 98304
    s_mul_i32 s45, s41, 128
    s_add_u32 s17, s17, s45
    s_mul_i32 s19, s42, 6144
    s_add_u32 s19, s19, 16384
    v_add_u32 v20, s17, v20
    s_mul_i32 s17, s21, 393216
    v_add_u32 v8, 4096, v20
    v_add_u32 v9, 5120, v20
    v_add_u32 v10, 6144, v20
    v_xor_b32 v20, 64, v20
    v_add_u32 v11, 50176, v20
    v_add_u32 v12, 55296, v20
    v_add_u32 v13, 56320, v20
    s_sub_u32 s17, s17, 393216
    s_sub_u32 s16, s16, 128
    s_waitcnt lgkmcnt(0)
    s_mov_b32 s4, s64
    s_and_b32 s5, s65, 0xffff
    s_mov_b32 s6, 4194304
    s_mov_b32 s7, 0x20000
    s_sub_u32 s8, s66, 4096
    s_subb_u32 s9, s67, 0
    s_and_b32 s9, s9, 0xffff
    s_mov_b32 s10, 6295552
    s_mov_b32 s11, 0x20000
    s_add_u32 s84, s82, 43515904
    s_addc_u32 s85, s83, 0
    s_and_b32 s85, s85, 0xffff
    s_mov_b32 s86, 98304
    s_mov_b32 s87, 0x20000
    s_lshl_b32 s47, s2, 2
    s_add_u32 s47, s47, s42
    s_cmp_lg_u32 s47, 3
    s_cbranch_scc1 sequential_preLN__softmax_full_mha__glu_gated_glu__prompt_kernel_noinit
    v_lshlrev_b32 v20, 8, v1
    v_mov_b32 v21, 0
    s_mov_b32 s45, 16384
    buffer_store_dword v21, v20, s[84:87], 0 offen sc1
    buffer_store_dword v21, v20, s[84:87], s45 offen sc1
sequential_preLN__softmax_full_mha__glu_gated_glu__prompt_kernel_noinit:
    s_add_u32 m0, s18, 0
    s_add_u32 s16, s16, 128
    s_and_b32 s16, s16, 2047
    buffer_load_dwordx4 v14, s[4:7], s16 offen offset:0 lds
    buffer_load_dwordx4 v15, s[4:7], s16 offen offset:1024 lds
    buffer_load_dwordx4 v16, s[4:7], s16 offen offset:2048 lds
    buffer_load_dwordx4 v17, s[4:7], s16 offen offset:3072 lds
    s_add_u32 m0, s19, 0
    s_add_u32 s17, s17, 393216
    s_cmp_eq_u32 s17, 6291456
    s_cselect_b32 s17, 0, s17
    buffer_load_dwordx4 v8, s[8:11], s17 offen offset:0 lds
    buffer_load_dwordx4 v9, s[8:11], s17 offen offset:1024 lds
    buffer_load_dwordx4 v10, s[8:11], s17 offen offset:2048 lds
    buffer_load_dwordx4 v11, s[8:11], s17 offen offset:3072 lds
    s_add_u32 m0, s19, 4096
    s_nop 0
    buffer_load_dwordx4 v12, s[8:11], s17 offen offset:0 lds
    buffer_load_dwordx4 v13, s[8:11], s17 offen offset:1024 lds
    v_lshrrev_b32 v20, 2, v1
    v_and_b32 v22, 3, v20
    v_lshrrev_b32 v21, 1, v20
    v_and_b32 v21, 3, v21
    s_lshl_b32 s45, s44, 1
    v_xor_b32 v21, s45, v21
    v_lshlrev_b32 v21, 5, v21
    v_lshlrev_b32 v20, 7, v22
    v_mul_u32_u24 v22, 3072, v2
    v_add_u32 v20, v20, v22
    v_and_b32 v22, 3, v1
    v_lshl_add_u32 v20, v22, 3, v20
    v_add_u32 v20, 16384, v20
    v_add_u32 v210, v20, v21
    v_xor_b32 v21, 32, v21
    v_add_u32 v211, v20, v21
    v_add_u32 v212, 40960, v208
    v_add_u32 v213, 40960, v209
    v_add_u32 v214, 40960, v210
    v_add_u32 v215, 40960, v211
    v_add_u32 v216, 81920, v208
    v_add_u32 v217, 81920, v209
    v_add_u32 v218, 81920, v210
    v_add_u32 v219, 81920, v211
    v_add_u32 v220, 122880, v208
    v_add_u32 v221, 122880, v209
    v_add_u32 v222, 122880, v210
    v_add_u32 v223, 122880, v211
    v_mov_b32 v32, 0
    v_mov_b32 v33, 0
    v_mov_b32 v34, 0
    v_mov_b32 v35, 0
    v_mov_b32 v36, 0
    v_mov_b32 v37, 0
    v_mov_b32 v38, 0
    v_mov_b32 v39, 0
    v_mov_b32 v40, 0
    v_mov_b32 v41, 0
    v_mov_b32 v42, 0
    v_mov_b32 v43, 0
    v_mov_b32 v44, 0
    v_mov_b32 v45, 0
    v_mov_b32 v46, 0
    v_mov_b32 v47, 0
    v_mov_b32 v48, 0
    v_mov_b32 v49, 0
    v_mov_b32 v50, 0
    v_mov_b32 v51, 0
    v_mov_b32 v52, 0
    v_mov_b32 v53, 0
    v_mov_b32 v54, 0
    v_mov_b32 v55, 0
    v_mov_b32 v56, 0
    v_mov_b32 v57, 0
    v_mov_b32 v58, 0
    v_mov_b32 v59, 0
    v_mov_b32 v60, 0
    v_mov_b32 v61, 0
    v_mov_b32 v62, 0
    v_mov_b32 v63, 0
    v_mov_b32 v64, 0
    v_mov_b32 v65, 0
    v_mov_b32 v66, 0
    v_mov_b32 v67, 0
    v_mov_b32 v68, 0
    v_mov_b32 v69, 0
    v_mov_b32 v70, 0
    v_mov_b32 v71, 0
    v_mov_b32 v72, 0
    v_mov_b32 v73, 0
    v_mov_b32 v74, 0
    v_mov_b32 v75, 0
    v_mov_b32 v76, 0
    v_mov_b32 v77, 0
    v_mov_b32 v78, 0
    v_mov_b32 v79, 0
    v_mov_b32 v80, 0
    v_mov_b32 v81, 0
    v_mov_b32 v82, 0
    v_mov_b32 v83, 0
    v_mov_b32 v84, 0
    v_mov_b32 v85, 0
    v_mov_b32 v86, 0
    v_mov_b32 v87, 0
    v_mov_b32 v88, 0
    v_mov_b32 v89, 0
    v_mov_b32 v90, 0
    v_mov_b32 v91, 0
    v_mov_b32 v92, 0
    v_mov_b32 v93, 0
    v_mov_b32 v94, 0
    v_mov_b32 v95, 0
    v_mov_b32 v96, 0
    v_mov_b32 v97, 0
    v_mov_b32 v98, 0
    v_mov_b32 v99, 0
    v_mov_b32 v100, 0
    v_mov_b32 v101, 0
    v_mov_b32 v102, 0
    v_mov_b32 v103, 0
    v_mov_b32 v104, 0
    v_mov_b32 v105, 0
    v_mov_b32 v106, 0
    v_mov_b32 v107, 0
    v_mov_b32 v108, 0
    v_mov_b32 v109, 0
    v_mov_b32 v110, 0
    v_mov_b32 v111, 0
    v_mov_b32 v112, 0
    v_mov_b32 v113, 0
    v_mov_b32 v114, 0
    v_mov_b32 v115, 0
    v_mov_b32 v116, 0
    v_mov_b32 v117, 0
    v_mov_b32 v118, 0
    v_mov_b32 v119, 0
    v_mov_b32 v120, 0
    v_mov_b32 v121, 0
    v_mov_b32 v122, 0
    v_mov_b32 v123, 0
    v_mov_b32 v124, 0
    v_mov_b32 v125, 0
    v_mov_b32 v126, 0
    v_mov_b32 v127, 0
    s_add_u32 s12, s82, 4194304
    s_addc_u32 s13, s83, 0
    s_and_b32 s13, s13, 0xffff
    s_mov_b32 s14, 12582912
    s_mov_b32 s15, 0x20000
    s_mov_b32 s88, s80
    s_and_b32 s89, s81, 0xffff
    s_mov_b32 s90, 256
    s_mov_b32 s91, 0x20000
    s_mov_b32 s52, s82
    s_and_b32 s53, s83, 0xffff
    s_mov_b32 s54, 262144
    s_mov_b32 s55, 0x20000
    s_add_u32 s56, s82, 1048576
    s_addc_u32 s57, s83, 0
    s_and_b32 s57, s57, 0xffff
    s_mov_b32 s58, 262144
    s_mov_b32 s59, 0x20000
    s_mov_b32 s60, s68
    s_and_b32 s61, s69, 0xffff
    s_mov_b32 s62, 2097152
    s_mov_b32 s63, 0x20000
    v_mov_b32 v20, 0x3f803f80
    v_mov_b32 v21, 0x3f803f80
    v_mov_b32 v22, 0x3f803f80
    v_mov_b32 v23, 0x3f803f80
    v_and_b32 v24, 3, v1
    v_cmp_eq_u32 s[22:23], 1, v2
    v_cmp_eq_u32 s[28:29], 1, v24
    v_cmp_eq_u32 s[24:25], 2, v2
    v_cmp_eq_u32 s[30:31], 2, v24
    v_cmp_eq_u32 s[26:27], 3, v2
    v_cmp_eq_u32 s[32:33], 3, v24
    v_and_b32 v24, 31, v1
    v_lshrrev_b32 v25, 5, v1
    v_lshlrev_b32 v24, 2, v24
    v_lshl_add_u32 v24, v25, 12, v24
    v_lshlrev_b32 v25, 4, v3
    s_lshl_b32 s48, s40, 14
    s_lshl_b32 s45, s43, 13
    s_lshl_b32 s50, s41, 8
    s_lshl_b32 s46, s44, 7
    s_add_u32 s48, s48, s45
    s_add_u32 s46, s46, s50
    s_add_u32 s48, s48, s46
    s_lshl_b32 s49, s41, 14
    s_lshl_b32 s51, s40, 10
    s_lshl_b32 s45, s42, 8
    s_add_u32 s49, s49, s51
    s_add_u32 s49, s49, s45
    v_lshl_add_u32 v28, v2, 12, v25
    s_lshl_b32 s45, s42, 16
    s_add_u32 s50, s50, s45
    s_add_u32 s51, s51, s45
    v_bfe_u32 v26, v0, 5, 2
    v_lshl_add_u32 v27, v26, 8, v25
    v_and_b32 v26, 1, v2
    v_lshl_add_u32 v27, v26, 3, v27
    v_add_u32 v27, 98304, v27
    v_mov_b32 v30, 0
    v_mov_b32 v31, 1
    s_sub_u32 s45, s41, s40
    s_add_u32 s45, s45, 64
    v_and_b32 v19, 1, v1
    v_mul_u32_u24 v19, s45, v19
    v_add_lshl_u32 v19, v19, s40, 8
    v_and_b32 v18, 0xc0, v0
    v_lshlrev_b32 v18, 2, v18
    s_cmp_eq_u32 s42, 0
    s_cselect_b32 s93, 3, 2
    s_mov_b32 s34, 0x00f0000f
    s_mov_b32 s35, 0xf0000f00
    s_add_u32 m0, s18, 40960
    s_add_u32 s16, s16, 128
    s_and_b32 s16, s16, 2047
    buffer_load_dwordx4 v14, s[4:7], s16 offen offset:0 lds
    buffer_load_dwordx4 v15, s[4:7], s16 offen offset:1024 lds
    buffer_load_dwordx4 v16, s[4:7], s16 offen offset:2048 lds
    buffer_load_dwordx4 v17, s[4:7], s16 offen offset:3072 lds
    s_add_u32 m0, s19, 40960
    s_add_u32 s17, s17, 393216
    s_cmp_eq_u32 s17, 6291456
    s_cselect_b32 s17, 0, s17
    buffer_load_dwordx4 v8, s[8:11], s17 offen offset:0 lds
    buffer_load_dwordx4 v9, s[8:11], s17 offen offset:1024 lds
    buffer_load_dwordx4 v10, s[8:11], s17 offen offset:2048 lds
    buffer_load_dwordx4 v11, s[8:11], s17 offen offset:3072 lds
    s_add_u32 m0, s19, 45056
    s_nop 0
    buffer_load_dwordx4 v12, s[8:11], s17 offen offset:0 lds
    buffer_load_dwordx4 v13, s[8:11], s17 offen offset:1024 lds
    s_add_u32 m0, s18, 81920
    s_add_u32 s16, s16, 128
    s_and_b32 s16, s16, 2047
    buffer_load_dwordx4 v14, s[4:7], s16 offen offset:0 lds
    buffer_load_dwordx4 v15, s[4:7], s16 offen offset:1024 lds
    buffer_load_dwordx4 v16, s[4:7], s16 offen offset:2048 lds
    buffer_load_dwordx4 v17, s[4:7], s16 offen offset:3072 lds
    s_waitcnt vmcnt(14)
    s_cmp_lg_u32 s47, 3
    s_cbranch_scc1 sequential_preLN__softmax_full_mha__glu_gated_glu__prompt_kernel_noinit2
    s_mov_b64 exec, 1
    buffer_store_dword v31, v30, s[88:91], 0 offen sc1
    s_mov_b64 exec, -1
sequential_preLN__softmax_full_mha__glu_gated_glu__prompt_kernel_noinit2:
    s_barrier
    ds_read_b128 v[128:131], v208 offset:0
    ds_read_b128 v[132:135], v208 offset:2048
    ds_read_b128 v[136:139], v208 offset:4096
    ds_read_b128 v[140:143], v208 offset:6144
    ds_read_b64_tr_b16 v[160:161], v210 offset:0
    ds_read_b64_tr_b16 v[162:163], v210 offset:512
    ds_read_b64_tr_b16 v[164:165], v211 offset:0
    ds_read_b64_tr_b16 v[166:167], v211 offset:512
    ds_read_b64_tr_b16 v[168:169], v210 offset:1024
    ds_read_b64_tr_b16 v[170:171], v210 offset:1536
    ds_read_b64_tr_b16 v[172:173], v211 offset:1024
    ds_read_b64_tr_b16 v[174:175], v211 offset:1536
    ds_read_b64_tr_b16 v[176:177], v210 offset:2048
    ds_read_b64_tr_b16 v[178:179], v210 offset:2560
    ds_read_b64_tr_b16 v[180:181], v211 offset:2048
    ds_read_b64_tr_b16 v[182:183], v211 offset:2560
    s_mov_b32 s20, 4
    s_waitcnt lgkmcnt(0)
    s_branch sequential_preLN__softmax_full_mha__glu_gated_glu__prompt_kernel_p1loop
sequential_preLN__softmax_full_mha__glu_gated_glu__prompt_kernel_sums:
    v_mfma_f32_16x16x32_bf16 a[0:3], v[20:23], v[160:163], 0
    v_mfma_f32_16x16x32_bf16 a[4:7], v[20:23], v[164:167], 0
    v_mfma_f32_16x16x32_bf16 a[8:11], v[20:23], v[168:171], 0
    v_mfma_f32_16x16x32_bf16 a[12:15], v[20:23], v[172:175], 0
    v_mfma_f32_16x16x32_bf16 a[16:19], v[20:23], v[176:179], 0
    v_mfma_f32_16x16x32_bf16 a[20:23], v[20:23], v[180:183], 0
    v_mfma_f32_16x16x32_bf16 a[24:27], v[20:23], v[128:131], 0
    v_mfma_f32_16x16x32_bf16 a[40:43], v[128:131], v[128:131], 0
    v_mfma_f32_16x16x32_bf16 a[28:31], v[20:23], v[132:135], 0
    v_mfma_f32_16x16x32_bf16 a[44:47], v[132:135], v[132:135], 0
    v_mfma_f32_16x16x32_bf16 a[32:35], v[20:23], v[136:139], 0
    v_mfma_f32_16x16x32_bf16 a[48:51], v[136:139], v[136:139], 0
    v_mfma_f32_16x16x32_bf16 a[36:39], v[20:23], v[140:143], 0
    v_mfma_f32_16x16x32_bf16 a[52:55], v[140:143], v[140:143], 0
    v_mfma_f32_16x16x32_bf16 a[0:3], v[20:23], v[184:187], a[0:3]
    v_mfma_f32_16x16x32_bf16 a[4:7], v[20:23], v[188:191], a[4:7]
    v_mfma_f32_16x16x32_bf16 a[8:11], v[20:23], v[192:195], a[8:11]
    v_mfma_f32_16x16x32_bf16 a[12:15], v[20:23], v[196:199], a[12:15]
    v_mfma_f32_16x16x32_bf16 a[16:19], v[20:23], v[200:203], a[16:19]
    v_mfma_f32_16x16x32_bf16 a[20:23], v[20:23], v[204:207], a[20:23]
    v_mfma_f32_16x16x32_bf16 a[24:27], v[20:23], v[144:147], a[24:27]
    v_mfma_f32_16x16x32_bf16 a[40:43], v[144:147], v[144:147], a[40:43]
    v_mfma_f32_16x16x32_bf16 a[28:31], v[20:23], v[148:151], a[28:31]
    v_mfma_f32_16x16x32_bf16 a[44:47], v[148:151], v[148:151], a[44:47]
    v_mfma_f32_16x16x32_bf16 a[32:35], v[20:23], v[152:155], a[32:35]
    v_mfma_f32_16x16x32_bf16 a[48:51], v[152:155], v[152:155], a[48:51]
    v_mfma_f32_16x16x32_bf16 a[36:39], v[20:23], v[156:159], a[36:39]
    v_mfma_f32_16x16x32_bf16 a[52:55], v[156:159], v[156:159], a[52:55]
    s_mov_b32 s45, s94
    s_mov_b32 s94, 7
    s_cmp_eq_u32 s45, 0
    s_cbranch_scc1 sequential_preLN__softmax_full_mha__glu_gated_glu__prompt_kernel_sumsr0
    s_cmp_eq_u32 s45, 1
    s_cbranch_scc1 sequential_preLN__softmax_full_mha__glu_gated_glu__prompt_kernel_sumsr1
    s_cmp_eq_u32 s45, 2
    s_cbranch_scc1 sequential_preLN__softmax_full_mha__glu_gated_glu__prompt_kernel_sumsr2
    s_branch sequential_preLN__softmax_full_mha__glu_gated_glu__prompt_kernel_sumsr3
sequential_preLN__softmax_full_mha__glu_gated_glu__prompt_kernel_red2:
    ds_read2st64_b64 v[224:227], v27 offset0:4 offset1:6
    ds_read2st64_b64 v[228:231], v27 offset0:8 offset1:10
    ds_read2st64_b32 v[240:241], v20 offset0:24 offset1:28
    ds_read2st64_b32 v[242:243], v20 offset0:32 offset1:36
    v_mfma_f32_16x16x32_bf16 v[44:47], v[184:187], v[156:159], v[44:47]
    s_lshl_b32 s45, s44, 7
    s_lshl_b32 s46, s43, 8
    v_mfma_f32_16x16x32_bf16 v[48:51], v[188:191], v[144:147], v[48:51]
    s_add_u32 s45, s45, 98304
    v_mfma_f32_16x16x32_bf16 v[52:55], v[188:191], v[148:151], v[52:55]
    s_add_u32 s46, s46, 98304
    v_mfma_f32_16x16x32_bf16 v[56:59], v[188:191], v[152:155], v[56:59]
    v_lshl_add_u32 v22, v2, 4, s45
    v_mfma_f32_16x16x32_bf16 v[60:63], v[188:191], v[156:159], v[60:63]
    v_lshl_add_u32 v23, v3, 2, s45
    v_lshl_add_u32 v24, v3, 2, s46
    v_mfma_f32_16x16x32_bf16 v[64:67], v[192:195], v[144:147], v[64:67]
    v_lshl_add_u32 v25, v2, 4, s46
    v_mfma_f32_16x16x32_bf16 v[68:71], v[192:195], v[148:151], v[68:71]
    s_waitcnt lgkmcnt(0)
    v_mfma_f32_16x16x32_bf16 v[72:75], v[192:195], v[152:155], v[72:75]
    v_pk_add_f32 v[224:225], v[224:225], v[226:227] op_sel:[0,0] op_sel_hi:[1,1]
    v_mfma_f32_16x16x32_bf16 v[76:79], v[192:195], v[156:159], v[76:79]
    v_pk_add_f32 v[228:229], v[228:229], v[230:231] op_sel:[0,0] op_sel_hi:[1,1]
    v_mfma_f32_16x16x32_bf16 v[80:83], v[196:199], v[144:147], v[80:83]
    v_pk_add_f32 v[240:241], v[240:241], v[242:243] op_sel:[0,0] op_sel_hi:[1,1]
    v_pk_add_f32 v[224:225], v[224:225], v[228:229] op_sel:[0,0] op_sel_hi:[1,1]
    v_mfma_f32_16x16x32_bf16 v[84:87], v[196:199], v[148:151], v[84:87]
    v_add_f32 v240, v240, v241
    v_mfma_f32_16x16x32_bf16 v[88:91], v[196:199], v[152:155], v[88:91]
    v_mul_f32 v224, 0xba800000, v224
    v_mfma_f32_16x16x32_bf16 v[92:95], v[196:199], v[156:159], v[92:95]
    v_mul_f32 v225, 0x3a800000, v225
    v_mfma_f32_16x16x32_bf16 v[96:99], v[144:147], v[200:203], v[96:99]
    ds_write_b32 v20, v240
    v_mfma_f32_16x16x32_bf16 v[100:103], v[148:151], v[200:203], v[100:103]
    v_fma_f32 v225, -v224, v224, v225
    v_max_f32 v225, 0, v225
    v_mfma_f32_16x16x32_bf16 v[104:107], v[152:155], v[200:203], v[104:107]
    v_add_f32 v225, 0x3727c5ac, v225
    v_mfma_f32_16x16x32_bf16 v[108:111], v[156:159], v[200:203], v[108:111]
    v_rsq_f32 v225, v225
    v_mfma_f32_16x16x32_bf16 v[112:115], v[144:147], v[204:207], v[112:115]
    s_nop 0
    v_mfma_f32_16x16x32_bf16 v[116:119], v[148:151], v[204:207], v[116:119]
    ds_write2st64_b32 v21, v224, v225 offset0:4 offset1:6
    v_mfma_f32_16x16x32_bf16 v[120:123], v[152:155], v[204:207], v[120:123]
    v_mfma_f32_16x16x32_bf16 v[124:127], v[156:159], v[204:207], v[124:127]
    s_sub_u32 s20, s20, 1
    s_cmp_lg_u32 s20, 0
    s_branch sequential_preLN__softmax_full_mha__glu_gated_glu__prompt_kernel_phend3
sequential_preLN__softmax_full_mha__glu_gated_glu__prompt_kernel_publish:
    v_mfma_f32_16x16x32_bf16 v[44:47], v[184:187], v[156:159], v[44:47]
    v_accvgpr_read_b32 v224, a0
    ds_read_b128 v[128:131], v212 offset:0
    v_accvgpr_read_b32 v225, a4
    v_mfma_f32_16x16x32_bf16 v[48:51], v[188:191], v[144:147], v[48:51]
    s_add_u32 m0, s18, 122880
    v_accvgpr_read_b32 v226, a8
    ds_read_b128 v[132:135], v212 offset:2048
    v_mfma_f32_16x16x32_bf16 v[52:55], v[188:191], v[148:151], v[52:55]
    v_accvgpr_read_b32 v227, a12
    v_accvgpr_read_b32 v228, a16
    ds_read_b128 v[136:139], v212 offset:4096
    v_mfma_f32_16x16x32_bf16 v[56:59], v[188:191], v[152:155], v[56:59]
    v_accvgpr_read_b32 v229, a20
    s_cmp_eq_u32 s44, 0
    s_cbranch_scc1 sequential_preLN__softmax_full_mha__glu_gated_glu__prompt_kernel_puba
    v_accvgpr_read_b32 v232, a32
    v_accvgpr_read_b32 v233, a48
    v_accvgpr_read_b32 v237, a49
    v_accvgpr_read_b32 v238, a50
    v_accvgpr_read_b32 v239, a51
    v_accvgpr_read_b32 v234, a36
    v_accvgpr_read_b32 v235, a52
    v_accvgpr_read_b32 v241, a53
    v_accvgpr_read_b32 v242, a54
    v_accvgpr_read_b32 v243, a55
    s_branch sequential_preLN__softmax_full_mha__glu_gated_glu__prompt_kernel_pubb
sequential_preLN__softmax_full_mha__glu_gated_glu__prompt_kernel_puba:
    v_accvgpr_read_b32 v232, a24
    v_accvgpr_read_b32 v233, a40
    v_accvgpr_read_b32 v237, a41
    v_accvgpr_read_b32 v238, a42
    v_accvgpr_read_b32 v239, a43
    v_accvgpr_read_b32 v234, a28
    v_accvgpr_read_b32 v235, a44
    v_accvgpr_read_b32 v241, a45
    v_accvgpr_read_b32 v242, a46
    v_accvgpr_read_b32 v243, a47
sequential_preLN__softmax_full_mha__glu_gated_glu__prompt_kernel_pubb:
    v_mfma_f32_16x16x32_bf16 v[60:63], v[188:191], v[156:159], v[60:63]
    ds_read_b128 v[140:143], v212 offset:6144
    s_add_u32 s16, s16, 128
    s_and_b32 s16, s16, 2047
    s_cmp_eq_u32 s43, 0
    s_cselect_b64 vcc, 0, -1
    v_mfma_f32_16x16x32_bf16 v[64:67], v[192:195], v[144:147], v[64:67]
    ds_read_b64_tr_b16 v[160:161], v214 offset:0
    v_cndmask_b32 v228, v228, v229, s[22:23]
    v_cndmask_b32 v224, v224, v225, s[22:23]
    v_mfma_f32_16x16x32_bf16 v[68:71], v[192:195], v[148:151], v[68:71]
    ds_read_b64_tr_b16 v[162:163], v214 offset:512
    v_cndmask_b32 v233, v233, v237, s[28:29]
    v_cndmask_b32 v235, v235, v241, s[28:29]
    v_mfma_f32_16x16x32_bf16 v[72:75], v[192:195], v[152:155], v[72:75]
    ds_read_b64_tr_b16 v[164:165], v215 offset:0
    buffer_load_dwordx4 v14, s[4:7], s16 offen offset:0 lds
    v_mfma_f32_16x16x32_bf16 v[76:79], v[192:195], v[156:159], v[76:79]
    v_cndmask_b32 v224, v224, v226, s[24:25]
    v_cndmask_b32 v233, v233, v238, s[30:31]
    ds_read_b64_tr_b16 v[166:167], v215 offset:512
    v_mfma_f32_16x16x32_bf16 v[80:83], v[196:199], v[144:147], v[80:83]
    v_cndmask_b32 v235, v235, v242, s[30:31]
    v_cndmask_b32 v224, v224, v227, s[26:27]
    ds_read_b64_tr_b16 v[168:169], v214 offset:1024
    v_mfma_f32_16x16x32_bf16 v[84:87], v[196:199], v[148:151], v[84:87]
    v_cndmask_b32 v233, v233, v239, s[32:33]
    buffer_load_dwordx4 v15, s[4:7], s16 offen offset:1024 lds
    v_cndmask_b32 v235, v235, v243, s[32:33]
    v_mfma_f32_16x16x32_bf16 v[88:91], v[196:199], v[152:155], v[88:91]
    ds_read_b64_tr_b16 v[170:171], v214 offset:1536
    v_cndmask_b32 v224, v224, v228, vcc
    v_mfma_f32_16x16x32_bf16 v[92:95], v[196:199], v[156:159], v[92:95]
    s_lshl_b32 s45, s2, 13
    ds_read_b64_tr_b16 v[172:173], v215 offset:1024
    v_lshlrev_b32 v26, 4, v0
    v_mfma_f32_16x16x32_bf16 v[96:99], v[144:147], v[200:203], v[96:99]
    buffer_store_dword v224, v24, s[56:59], s48 offen sc1
    ds_read_b64_tr_b16 v[174:175], v215 offset:1536
    buffer_load_dwordx4 v16, s[4:7], s16 offen offset:2048 lds
    v_mfma_f32_16x16x32_bf16 v[100:103], v[148:151], v[200:203], v[100:103]
    s_mov_b64 exec, s[34:35]
    buffer_store_dwordx4 v[232:235], v25, s[52:55], s49 offen sc1
    s_mov_b64 exec, -1
    s_nop 1
    ds_read_b64_tr_b16 v[176:177], v214 offset:2048
    s_lshl_b32 s46, s47, 6
    v_mfma_f32_16x16x32_bf16 v[104:107], v[152:155], v[200:203], v[104:107]
    s_add_u32 s46, s46, 32768
    ds_read_b64_tr_b16 v[178:179], v214 offset:2560
    v_mfma_f32_16x16x32_bf16 v[108:111], v[156:159], v[200:203], v[108:111]
    s_mov_b64 exec, 1
    buffer_store_dword v30, v30, s[84:87], s46 offen sc1
    s_mov_b64 exec, -1
    s_nop 1
    buffer_load_dword v29, v18, s[88:91], 0 offen sc1
    ds_read_b64_tr_b16 v[180:181], v215 offset:2048
    v_mfma_f32_16x16x32_bf16 v[112:115], v[144:147], v[204:207], v[112:115]
    buffer_load_dwordx4 v17, s[4:7], s16 offen offset:3072 lds
    buffer_load_dwordx4 a[100:103], v26, s[60:63], s45 offen
    s_add_u32 s45, s45, 4096
    v_mfma_f32_16x16x32_bf16 v[116:119], v[148:151], v[204:207], v[116:119]
    ds_read_b64_tr_b16 v[182:183], v215 offset:2560
    buffer_load_dwordx4 a[104:107], v26, s[60:63], s45 offen
    v_mfma_f32_16x16x32_bf16 v[120:123], v[152:155], v[204:207], v[120:123]
    v_mfma_f32_16x16x32_bf16 v[124:127], v[156:159], v[204:207], v[124:127]
    s_branch sequential_preLN__softmax_full_mha__glu_gated_glu__prompt_kernel_phend0
sequential_preLN__softmax_full_mha__glu_gated_glu__prompt_kernel_signal:
    s_cmp_eq_u32 s20, 2
    s_cbranch_scc1 sequential_preLN__softmax_full_mha__glu_gated_glu__prompt_kernel_look
    v_readfirstlane_b32 s45, v29
    s_cmp_eq_u32 s45, 1
    s_cbranch_scc1 sequential_preLN__softmax_full_mha__glu_gated_glu__prompt_kernel_sigi
    s_mov_b64 exec, 1
    s_mov_b32 s45, 0x20000
sequential_preLN__softmax_full_mha__glu_gated_glu__prompt_kernel_poll1:
    buffer_load_dword v31, v30, s[88:91], 0 offen sc1
    s_sub_u32 s45, s45, 1
    s_cbranch_scc1 sequential_preLN__softmax_full_mha__glu_gated_glu__prompt_kernel_poll1x
    s_waitcnt vmcnt(0)
    v_cmp_gt_u32 vcc, 1, v31
    s_and_b64 vcc, vcc, exec
    s_cbranch_scc1 sequential_preLN__softmax_full_mha__glu_gated_glu__prompt_kernel_poll1
sequential_preLN__softmax_full_mha__glu_gated_glu__prompt_kernel_poll1x:
    s_mov_b64 exec, -1
sequential_preLN__softmax_full_mha__glu_gated_glu__prompt_kernel_sigi:
    v_mov_b32 v31, 1
    s_mov_b64 exec, 3
    buffer_atomic_add v31, v19, s[84:87], 0 offen sc1
    s_mov_b64 exec, -1
    s_branch sequential_preLN__softmax_full_mha__glu_gated_glu__prompt_kernel_signalr2
sequential_preLN__softmax_full_mha__glu_gated_glu__prompt_kernel_look:
    v_mov_b32 v30, v19
    buffer_load_dword v18, v19, s[84:87], 0 offen sc1
    s_branch sequential_preLN__softmax_full_mha__glu_gated_glu__prompt_kernel_signalr2
sequential_preLN__softmax_full_mha__glu_gated_glu__prompt_kernel_fetch:
    v_cmp_gt_u32 vcc, 16, v18
    s_and_b64 vcc, vcc, exec
    s_cbranch_scc0 sequential_preLN__softmax_full_mha__glu_gated_glu__prompt_kernel_feg
    s_mov_b64 exec, 3
    s_mov_b32 s45, 0x20000
sequential_preLN__softmax_full_mha__glu_gated_glu__prompt_kernel_poll2:
    buffer_load_dword v31, v30, s[84:87], 0 offen sc1
    s_sub_u32 s45, s45, 1
    s_cbranch_scc1 sequential_preLN__softmax_full_mha__glu_gated_glu__prompt_kernel_poll2x
    s_waitcnt vmcnt(0)
    v_cmp_gt_u32 vcc, 16, v31
    s_and_b64 vcc, vcc, exec
    s_cbranch_scc1 sequential_preLN__softmax_full_mha__glu_gated_glu__prompt_kernel_poll2
sequential_preLN__softmax_full_mha__glu_gated_glu__prompt_kernel_poll2x:
    s_mov_b64 exec, -1
sequential_preLN__softmax_full_mha__glu_gated_glu__prompt_kernel_feg:
    v_mfma_f32_16x16x32_bf16 v[48:51], v[188:191], v[144:147], v[48:51]
    ds_read_b128 v[128:131], v212 offset:0
    buffer_load_dwordx4 v[224:227], v4, s[52:55], s51 offen sc1
    v_mfma_f32_16x16x32_bf16 v[52:55], v[188:191], v[148:151], v[52:55]
    s_add_u32 m0, s18, 122880
    ds_read_b128 v[132:135], v212 offset:2048
    v_mfma_f32_16x16x32_bf16 v[56:59], v[188:191], v[152:155], v[56:59]
    s_add_u32 s51, s51, 16384
    ds_read_b128 v[136:139], v212 offset:4096
    v_mfma_f32_16x16x32_bf16 v[60:63], v[188:191], v[156:159], v[60:63]
    buffer_load_dwordx4 v[240:243], v28, s[56:59], s50 offen sc1
    ds_read_b128 v[140:143], v212 offset:6144
    v_mfma_f32_16x16x32_bf16 v[64:67], v[192:195], v[144:147], v[64:67]
    s_add_u32 s50, s50, 16384
    s_add_u32 s16, s16, 128
    s_and_b32 s16, s16, 2047
    v_mfma_f32_16x16x32_bf16 v[68:71], v[192:195], v[148:151], v[68:71]
    ds_read_b64_tr_b16 v[160:161], v214 offset:0
    buffer_load_dwordx4 v[228:231], v4, s[52:55], s51 offen sc1
    v_mfma_f32_16x16x32_bf16 v[72:75], v[192:195], v[152:155], v[72:75]
    ds_read_b64_tr_b16 v[162:163], v214 offset:512
    s_add_u32 s51, s51, 16384
    v_mfma_f32_16x16x32_bf16 v[76:79], v[192:195], v[156:159], v[76:79]
    ds_read_b64_tr_b16 v[164:165], v215 offset:0
    buffer_load_dwordx4 v[244:247], v28, s[56:59], s50 offen sc1
    v_mfma_f32_16x16x32_bf16 v[80:83], v[196:199], v[144:147], v[80:83]
    buffer_load_dwordx4 v14, s[4:7], s16 offen offset:0 lds
    ds_read_b64_tr_b16 v[166:167], v215 offset:512
    v_mfma_f32_16x16x32_bf16 v[84:87], v[196:199], v[148:151], v[84:87]
    s_add_u32 s50, s50, 16384
    ds_read_b64_tr_b16 v[168:169], v214 offset:1024
    v_mfma_f32_16x16x32_bf16 v[88:91], v[196:199], v[152:155], v[88:91]
    buffer_load_dwordx4 v[232:235], v4, s[52:55], s51 offen sc1
    buffer_load_dwordx4 v15, s[4:7], s16 offen offset:1024 lds
    v_mfma_f32_16x16x32_bf16 v[92:95], v[196:199], v[156:159], v[92:95]
    ds_read_b64_tr_b16 v[170:171], v214 offset:1536
    s_add_u32 s51, s51, 16384
    v_mfma_f32_16x16x32_bf16 v[96:99], v[144:147], v[200:203], v[96:99]
    ds_read_b64_tr_b16 v[172:173], v215 offset:1024
    buffer_load_dwordx4 v[248:251], v28, s[56:59], s50 offen sc1
    v_mfma_f32_16x16x32_bf16 v[100:103], v[148:151], v[200:203], v[100:103]
    ds_read_b64_tr_b16 v[174:175], v215 offset:1536
    s_add_u32 s50, s50, 16384
    v_mfma_f32_16x16x32_bf16 v[104:107], v[152:155], v[200:203], v[104:107]
    buffer_load_dwordx4 v16, s[4:7], s16 offen offset:2048 lds
    ds_read_b64_tr_b16 v[176:177], v214 offset:2048
    v_mfma_f32_16x16x32_bf16 v[108:111], v[156:159], v[200:203], v[108:111]
    buffer_load_dwordx4 v[236:239], v4, s[52:55], s51 offen sc1
    ds_read_b64_tr_b16 v[178:179], v214 offset:2560
    v_mfma_f32_16x16x32_bf16 v[112:115], v[144:147], v[204:207], v[112:115]
    s_add_u32 s51, s51, 16384
    ds_read_b64_tr_b16 v[180:181], v215 offset:2048
    v_mfma_f32_16x16x32_bf16 v[116:119], v[148:151], v[204:207], v[116:119]
    buffer_load_dwordx4 v[252:255], v28, s[56:59], s50 offen sc1
    buffer_load_dwordx4 v17, s[4:7], s16 offen offset:3072 lds
    v_mfma_f32_16x16x32_bf16 v[120:123], v[152:155], v[204:207], v[120:123]
    ds_read_b64_tr_b16 v[182:183], v215 offset:2560
    s_add_u32 s50, s50, 16384
    v_mfma_f32_16x16x32_bf16 v[124:127], v[156:159], v[204:207], v[124:127]
    s_branch sequential_preLN__softmax_full_mha__glu_gated_glu__prompt_kernel_phend0
sequential_preLN__softmax_full_mha__glu_gated_glu__prompt_kernel_red1:
    v_mfma_f32_16x16x32_bf16 v[48:51], v[188:191], v[144:147], v[48:51]
    v_pk_add_f32 v[224:225], v[224:225], v[232:233] op_sel:[0,0] op_sel_hi:[1,1]
    ds_read_b128 v[128:131], v220 offset:0
    v_mfma_f32_16x16x32_bf16 v[52:55], v[188:191], v[148:151], v[52:55]
    v_pk_add_f32 v[226:227], v[226:227], v[234:235] op_sel:[0,0] op_sel_hi:[1,1]
    ds_read_b128 v[132:135], v220 offset:2048
    v_mfma_f32_16x16x32_bf16 v[56:59], v[188:191], v[152:155], v[56:59]
    v_pk_add_f32 v[228:229], v[228:229], v[236:237] op_sel:[0,0] op_sel_hi:[1,1]
    ds_read_b128 v[136:139], v220 offset:4096
    v_mfma_f32_16x16x32_bf16 v[60:63], v[188:191], v[156:159], v[60:63]
    v_pk_add_f32 v[230:231], v[230:231], v[238:239] op_sel:[0,0] op_sel_hi:[1,1]
    ds_read_b128 v[140:143], v220 offset:6144
    v_mfma_f32_16x16x32_bf16 v[64:67], v[192:195], v[144:147], v[64:67]
    v_pk_add_f32 v[240:241], v[240:241], v[248:249] op_sel:[0,0] op_sel_hi:[1,1]
    v_pk_add_f32 v[242:243], v[242:243], v[250:251] op_sel:[0,0] op_sel_hi:[1,1]
    v_mfma_f32_16x16x32_bf16 v[68:71], v[192:195], v[148:151], v[68:71]
    ds_read_b64_tr_b16 v[160:161], v222 offset:0
    v_pk_add_f32 v[244:245], v[244:245], v[252:253] op_sel:[0,0] op_sel_hi:[1,1]
    v_mfma_f32_16x16x32_bf16 v[72:75], v[192:195], v[152:155], v[72:75]
    ds_read_b64_tr_b16 v[162:163], v222 offset:512
    v_pk_add_f32 v[246:247], v[246:247], v[254:255] op_sel:[0,0] op_sel_hi:[1,1]
    v_mfma_f32_16x16x32_bf16 v[76:79], v[192:195], v[156:159], v[76:79]
    ds_read_b64_tr_b16 v[164:165], v223 offset:0
    v_pk_add_f32 v[224:225], v[224:225], v[228:229] op_sel:[0,0] op_sel_hi:[1,1]
    v_mfma_f32_16x16x32_bf16 v[80:83], v[196:199], v[144:147], v[80:83]
    ds_read_b64_tr_b16 v[166:167], v223 offset:512
    v_pk_add_f32 v[226:227], v[226:227], v[230:231] op_sel:[0,0] op_sel_hi:[1,1]
    v_mfma_f32_16x16x32_bf16 v[84:87], v[196:199], v[148:151], v[84:87]
    v_pk_add_f32 v[240:241], v[240:241], v[244:245] op_sel:[0,0] op_sel_hi:[1,1]
    v_mfma_f32_16x16x32_bf16 v[88:91], v[196:199], v[152:155], v[88:91]
    ds_read_b64_tr_b16 v[168:169], v222 offset:1024
    v_pk_add_f32 v[242:243], v[242:243], v[246:247] op_sel:[0,0] op_sel_hi:[1,1]
    v_mfma_f32_16x16x32_bf16 v[92:95], v[196:199], v[156:159], v[92:95]
    ds_read_b64_tr_b16 v[170:171], v222 offset:1536
    v_lshlrev_b32 v26, 4, v0
    v_mfma_f32_16x16x32_bf16 v[96:99], v[144:147], v[200:203], v[96:99]
    ds_read_b64_tr_b16 v[172:173], v223 offset:1024
    v_add_u32 v26, 98304, v26
    v_mfma_f32_16x16x32_bf16 v[100:103], v[148:151], v[200:203], v[100:103]
    ds_read_b64_tr_b16 v[174:175], v223 offset:1536
    ds_write_b128 v26, v[224:227] offset:2048
    v_mfma_f32_16x16x32_bf16 v[104:107], v[152:155], v[200:203], v[104:107]
    ds_write_b128 v26, v[240:243] offset:6144
    ds_read_b64_tr_b16 v[176:177], v222 offset:2048
    v_mfma_f32_16x16x32_bf16 v[108:111], v[156:159], v[200:203], v[108:111]
    v_lshlrev_b32 v20, 2, v0
    ds_read_b64_tr_b16 v[178:179], v222 offset:2560
    v_mfma_f32_16x16x32_bf16 v[112:115], v[144:147], v[204:207], v[112:115]
    v_and_b32 v21, 0x1fc, v20
    ds_read_b64_tr_b16 v[180:181], v223 offset:2048
    v_mfma_f32_16x16x32_bf16 v[116:119], v[148:151], v[204:207], v[116:119]
    v_add_u32 v20, 98304, v20
    ds_read_b64_tr_b16 v[182:183], v223 offset:2560
    v_mfma_f32_16x16x32_bf16 v[120:123], v[152:155], v[204:207], v[120:123]
    v_add_u32 v21, 98304, v21
    v_mfma_f32_16x16x32_bf16 v[124:127], v[156:159], v[204:207], v[124:127]
    s_branch sequential_preLN__softmax_full_mha__glu_gated_glu__prompt_kernel_phend2
sequential_preLN__softmax_full_mha__glu_gated_glu__prompt_kernel_p1loop:
    v_mfma_f32_16x16x32_bf16 v[32:35], v[160:163], v[128:131], v[32:35]
    ds_read_b128 v[144:147], v209 offset:0
    s_add_u32 m0, s19, 81920
    v_mfma_f32_16x16x32_bf16 v[36:39], v[160:163], v[132:135], v[36:39]
    ds_read_b128 v[148:151], v209 offset:2048
    v_mfma_f32_16x16x32_bf16 v[40:43], v[160:163], v[136:139], v[40:43]
    s_add_u32 s17, s17, 393216
    ds_read_b128 v[152:155], v209 offset:4096
    v_mfma_f32_16x16x32_bf16 v[44:47], v[160:163], v[140:143], v[44:47]
    ds_read_b128 v[156:159], v209 offset:6144
    v_mfma_f32_16x16x32_bf16 v[48:51], v[164:167], v[128:131], v[48:51]
    s_cmp_eq_u32 s17, 6291456
    s_cselect_b32 s17, 0, s17
    v_mfma_f32_16x16x32_bf16 v[52:55], v[164:167], v[132:135], v[52:55]
    ds_read_b64_tr_b16 v[184:185], v210 offset:12288
    buffer_load_dwordx4 v8, s[8:11], s17 offen offset:0 lds
    v_mfma_f32_16x16x32_bf16 v[56:59], v[164:167], v[136:139], v[56:59]
    ds_read_b64_tr_b16 v[186:187], v210 offset:12800
    v_mfma_f32_16x16x32_bf16 v[60:63], v[164:167], v[140:143], v[60:63]
    ds_read_b64_tr_b16 v[188:189], v211 offset:12288
    v_mfma_f32_16x16x32_bf16 v[64:67], v[168:171], v[128:131], v[64:67]
    buffer_load_dwordx4 v9, s[8:11], s17 offen offset:1024 lds
    ds_read_b64_tr_b16 v[190:191], v211 offset:12800
    v_mfma_f32_16x16x32_bf16 v[68:71], v[168:171], v[132:135], v[68:71]
    buffer_load_dwordx4 v10, s[8:11], s17 offen offset:2048 lds
    v_mfma_f32_16x16x32_bf16 v[72:75], v[168:171], v[136:139], v[72:75]
    ds_read_b64_tr_b16 v[192:193], v210 offset:13312
    v_mfma_f32_16x16x32_bf16 v[76:79], v[168:171], v[140:143], v[76:79]
    buffer_load_dwordx4 v11, s[8:11], s17 offen offset:3072 lds
    ds_read_b64_tr_b16 v[194:195], v210 offset:13824
    v_mfma_f32_16x16x32_bf16 v[80:83], v[172:175], v[128:131], v[80:83]
    ds_read_b64_tr_b16 v[196:197], v211 offset:13312
    v_mfma_f32_16x16x32_bf16 v[84:87], v[172:175], v[132:135], v[84:87]
    s_add_u32 m0, s19, 86016
    v_mfma_f32_16x16x32_bf16 v[88:91], v[172:175], v[136:139], v[88:91]
    ds_read_b64_tr_b16 v[198:199], v211 offset:13824
    s_nop 0
    v_mfma_f32_16x16x32_bf16 v[92:95], v[172:175], v[140:143], v[92:95]
    ds_read_b64_tr_b16 v[200:201], v210 offset:14336
    v_mfma_f32_16x16x32_bf16 v[96:99], v[128:131], v[176:179], v[96:99]
    ds_read_b64_tr_b16 v[202:203], v210 offset:14848
    v_mfma_f32_16x16x32_bf16 v[100:103], v[132:135], v[176:179], v[100:103]
    buffer_load_dwordx4 v12, s[8:11], s17 offen offset:0 lds
    ds_read_b64_tr_b16 v[204:205], v211 offset:14336
    v_mfma_f32_16x16x32_bf16 v[104:107], v[136:139], v[176:179], v[104:107]
    buffer_load_dwordx4 v13, s[8:11], s17 offen offset:1024 lds
    v_mfma_f32_16x16x32_bf16 v[108:111], v[140:143], v[176:179], v[108:111]
    ds_read_b64_tr_b16 v[206:207], v211 offset:14848
    v_mfma_f32_16x16x32_bf16 v[112:115], v[128:131], v[180:183], v[112:115]
    v_mfma_f32_16x16x32_bf16 v[116:119], v[132:135], v[180:183], v[116:119]
    v_mfma_f32_16x16x32_bf16 v[120:123], v[136:139], v[180:183], v[120:123]
    v_mfma_f32_16x16x32_bf16 v[124:127], v[140:143], v[180:183], v[124:127]
    s_waitcnt lgkmcnt(0)
    v_mfma_f32_16x16x32_bf16 v[32:35], v[184:187], v[144:147], v[32:35]
    s_waitcnt vmcnt(10)
    s_barrier
    v_mfma_f32_16x16x32_bf16 v[36:39], v[184:187], v[148:151], v[36:39]
    s_cmp_eq_u32 s94, 0
    s_cbranch_scc1 sequential_preLN__softmax_full_mha__glu_gated_glu__prompt_kernel_sums
sequential_preLN__softmax_full_mha__glu_gated_glu__prompt_kernel_sumsr0:
    v_mfma_f32_16x16x32_bf16 v[40:43], v[184:187], v[152:155], v[40:43]
    s_cmp_eq_u32 s20, 3
    s_cbranch_scc1 sequential_preLN__softmax_full_mha__glu_gated_glu__prompt_kernel_publish
sequential_preLN__softmax_full_mha__glu_gated_glu__prompt_kernel_publishr0:
    v_mfma_f32_16x16x32_bf16 v[44:47], v[184:187], v[156:159], v[44:47]
    s_cmp_eq_u32 s20, 1
    s_cbranch_scc1 sequential_preLN__softmax_full_mha__glu_gated_glu__prompt_kernel_fetch
sequential_preLN__softmax_full_mha__glu_gated_glu__prompt_kernel_fetchr0:
    v_mfma_f32_16x16x32_bf16 v[48:51], v[188:191], v[144:147], v[48:51]
    ds_read_b128 v[128:131], v212 offset:0
    s_add_u32 m0, s18, 122880
    v_mfma_f32_16x16x32_bf16 v[52:55], v[188:191], v[148:151], v[52:55]
    ds_read_b128 v[132:135], v212 offset:2048
    v_mfma_f32_16x16x32_bf16 v[56:59], v[188:191], v[152:155], v[56:59]
    ds_read_b128 v[136:139], v212 offset:4096
    v_mfma_f32_16x16x32_bf16 v[60:63], v[188:191], v[156:159], v[60:63]
    ds_read_b128 v[140:143], v212 offset:6144
    s_add_u32 s16, s16, 128
    s_and_b32 s16, s16, 2047
    v_mfma_f32_16x16x32_bf16 v[64:67], v[192:195], v[144:147], v[64:67]
    ds_read_b64_tr_b16 v[160:161], v214 offset:0
    v_mfma_f32_16x16x32_bf16 v[68:71], v[192:195], v[148:151], v[68:71]
    ds_read_b64_tr_b16 v[162:163], v214 offset:512
    v_mfma_f32_16x16x32_bf16 v[72:75], v[192:195], v[152:155], v[72:75]
    ds_read_b64_tr_b16 v[164:165], v215 offset:0
    buffer_load_dwordx4 v14, s[4:7], s16 offen offset:0 lds
    v_mfma_f32_16x16x32_bf16 v[76:79], v[192:195], v[156:159], v[76:79]
    ds_read_b64_tr_b16 v[166:167], v215 offset:512
    v_mfma_f32_16x16x32_bf16 v[80:83], v[196:199], v[144:147], v[80:83]
    ds_read_b64_tr_b16 v[168:169], v214 offset:1024
    v_mfma_f32_16x16x32_bf16 v[84:87], v[196:199], v[148:151], v[84:87]
    buffer_load_dwordx4 v15, s[4:7], s16 offen offset:1024 lds
    v_mfma_f32_16x16x32_bf16 v[88:91], v[196:199], v[152:155], v[88:91]
    ds_read_b64_tr_b16 v[170:171], v214 offset:1536
    ds_read_b64_tr_b16 v[172:173], v215 offset:1024
    v_mfma_f32_16x16x32_bf16 v[92:95], v[196:199], v[156:159], v[92:95]
    ds_read_b64_tr_b16 v[174:175], v215 offset:1536
    v_mfma_f32_16x16x32_bf16 v[96:99], v[144:147], v[200:203], v[96:99]
    buffer_load_dwordx4 v16, s[4:7], s16 offen offset:2048 lds
    v_mfma_f32_16x16x32_bf16 v[100:103], v[148:151], v[200:203], v[100:103]
    ds_read_b64_tr_b16 v[176:177], v214 offset:2048
    ds_read_b64_tr_b16 v[178:179], v214 offset:2560
    v_mfma_f32_16x16x32_bf16 v[104:107], v[152:155], v[200:203], v[104:107]
    ds_read_b64_tr_b16 v[180:181], v215 offset:2048
    v_mfma_f32_16x16x32_bf16 v[108:111], v[156:159], v[200:203], v[108:111]
    buffer_load_dwordx4 v17, s[4:7], s16 offen offset:3072 lds
    v_mfma_f32_16x16x32_bf16 v[112:115], v[144:147], v[204:207], v[112:115]
    ds_read_b64_tr_b16 v[182:183], v215 offset:2560
    v_mfma_f32_16x16x32_bf16 v[116:119], v[148:151], v[204:207], v[116:119]
    v_mfma_f32_16x16x32_bf16 v[120:123], v[152:155], v[204:207], v[120:123]
    v_mfma_f32_16x16x32_bf16 v[124:127], v[156:159], v[204:207], v[124:127]
sequential_preLN__softmax_full_mha__glu_gated_glu__prompt_kernel_phend0:
    s_waitcnt lgkmcnt(0)
    v_mfma_f32_16x16x32_bf16 v[32:35], v[160:163], v[128:131], v[32:35]
    ds_read_b128 v[144:147], v213 offset:0
    s_add_u32 m0, s19, 122880
    v_mfma_f32_16x16x32_bf16 v[36:39], v[160:163], v[132:135], v[36:39]
    ds_read_b128 v[148:151], v213 offset:2048
    v_mfma_f32_16x16x32_bf16 v[40:43], v[160:163], v[136:139], v[40:43]
    s_add_u32 s17, s17, 393216
    ds_read_b128 v[152:155], v213 offset:4096
    v_mfma_f32_16x16x32_bf16 v[44:47], v[160:163], v[140:143], v[44:47]
    ds_read_b128 v[156:159], v213 offset:6144
    v_mfma_f32_16x16x32_bf16 v[48:51], v[164:167], v[128:131], v[48:51]
    s_cmp_eq_u32 s17, 6291456
    s_cselect_b32 s17, 0, s17
    v_mfma_f32_16x16x32_bf16 v[52:55], v[164:167], v[132:135], v[52:55]
    ds_read_b64_tr_b16 v[184:185], v214 offset:12288
    buffer_load_dwordx4 v8, s[8:11], s17 offen offset:0 lds
    v_mfma_f32_16x16x32_bf16 v[56:59], v[164:167], v[136:139], v[56:59]
    ds_read_b64_tr_b16 v[186:187], v214 offset:12800
    v_mfma_f32_16x16x32_bf16 v[60:63], v[164:167], v[140:143], v[60:63]
    ds_read_b64_tr_b16 v[188:189], v215 offset:12288
    v_mfma_f32_16x16x32_bf16 v[64:67], v[168:171], v[128:131], v[64:67]
    buffer_load_dwordx4 v9, s[8:11], s17 offen offset:1024 lds
    ds_read_b64_tr_b16 v[190:191], v215 offset:12800
    v_mfma_f32_16x16x32_bf16 v[68:71], v[168:171], v[132:135], v[68:71]
    buffer_load_dwordx4 v10, s[8:11], s17 offen offset:2048 lds
    v_mfma_f32_16x16x32_bf16 v[72:75], v[168:171], v[136:139], v[72:75]
    ds_read_b64_tr_b16 v[192:193], v214 offset:13312
    v_mfma_f32_16x16x32_bf16 v[76:79], v[168:171], v[140:143], v[76:79]
    buffer_load_dwordx4 v11, s[8:11], s17 offen offset:3072 lds
    ds_read_b64_tr_b16 v[194:195], v214 offset:13824
    v_mfma_f32_16x16x32_bf16 v[80:83], v[172:175], v[128:131], v[80:83]
    ds_read_b64_tr_b16 v[196:197], v215 offset:13312
    v_mfma_f32_16x16x32_bf16 v[84:87], v[172:175], v[132:135], v[84:87]
    s_add_u32 m0, s19, 126976
    v_mfma_f32_16x16x32_bf16 v[88:91], v[172:175], v[136:139], v[88:91]
    ds_read_b64_tr_b16 v[198:199], v215 offset:13824
    s_nop 0
    v_mfma_f32_16x16x32_bf16 v[92:95], v[172:175], v[140:143], v[92:95]
    ds_read_b64_tr_b16 v[200:201], v214 offset:14336
    v_mfma_f32_16x16x32_bf16 v[96:99], v[128:131], v[176:179], v[96:99]
    ds_read_b64_tr_b16 v[202:203], v214 offset:14848
    v_mfma_f32_16x16x32_bf16 v[100:103], v[132:135], v[176:179], v[100:103]
    buffer_load_dwordx4 v12, s[8:11], s17 offen offset:0 lds
    ds_read_b64_tr_b16 v[204:205], v215 offset:14336
    v_mfma_f32_16x16x32_bf16 v[104:107], v[136:139], v[176:179], v[104:107]
    buffer_load_dwordx4 v13, s[8:11], s17 offen offset:1024 lds
    v_mfma_f32_16x16x32_bf16 v[108:111], v[140:143], v[176:179], v[108:111]
    ds_read_b64_tr_b16 v[206:207], v215 offset:14848
    v_mfma_f32_16x16x32_bf16 v[112:115], v[128:131], v[180:183], v[112:115]
    v_mfma_f32_16x16x32_bf16 v[116:119], v[132:135], v[180:183], v[116:119]
    v_mfma_f32_16x16x32_bf16 v[120:123], v[136:139], v[180:183], v[120:123]
    v_mfma_f32_16x16x32_bf16 v[124:127], v[140:143], v[180:183], v[124:127]
    s_waitcnt lgkmcnt(0)
    v_mfma_f32_16x16x32_bf16 v[32:35], v[184:187], v[144:147], v[32:35]
    s_cmp_eq_u32 s20, 3
    s_cbranch_scc1 sequential_preLN__softmax_full_mha__glu_gated_glu__prompt_kernel_alt16
    s_cmp_eq_u32 s20, 1
    s_cbranch_scc1 sequential_preLN__softmax_full_mha__glu_gated_glu__prompt_kernel_alt18
    s_waitcnt vmcnt(10)
sequential_preLN__softmax_full_mha__glu_gated_glu__prompt_kernel_alt16:
    s_waitcnt vmcnt(16)
sequential_preLN__softmax_full_mha__glu_gated_glu__prompt_kernel_alt18:
    s_waitcnt vmcnt(18)
    s_barrier
    v_mfma_f32_16x16x32_bf16 v[36:39], v[184:187], v[148:151], v[36:39]
    s_cmp_eq_u32 s94, 1
    s_cbranch_scc1 sequential_preLN__softmax_full_mha__glu_gated_glu__prompt_kernel_sums
sequential_preLN__softmax_full_mha__glu_gated_glu__prompt_kernel_sumsr1:
    v_mfma_f32_16x16x32_bf16 v[40:43], v[184:187], v[152:155], v[40:43]
    s_cmp_eq_u32 s20, 1
    s_cselect_b32 s6, 0, s6
    s_cselect_b32 s10, 0, s10
    v_mfma_f32_16x16x32_bf16 v[44:47], v[184:187], v[156:159], v[44:47]
    ds_read_b128 v[128:131], v216 offset:0
    s_add_u32 m0, s18, 0
    v_mfma_f32_16x16x32_bf16 v[48:51], v[188:191], v[144:147], v[48:51]
    ds_read_b128 v[132:135], v216 offset:2048
    v_mfma_f32_16x16x32_bf16 v[52:55], v[188:191], v[148:151], v[52:55]
    ds_read_b128 v[136:139], v216 offset:4096
    v_mfma_f32_16x16x32_bf16 v[56:59], v[188:191], v[152:155], v[56:59]
    ds_read_b128 v[140:143], v216 offset:6144
    s_add_u32 s16, s16, 128
    s_and_b32 s16, s16, 2047
    v_mfma_f32_16x16x32_bf16 v[60:63], v[188:191], v[156:159], v[60:63]
    ds_read_b64_tr_b16 v[160:161], v218 offset:0
    v_mfma_f32_16x16x32_bf16 v[64:67], v[192:195], v[144:147], v[64:67]
    ds_read_b64_tr_b16 v[162:163], v218 offset:512
    v_mfma_f32_16x16x32_bf16 v[68:71], v[192:195], v[148:151], v[68:71]
    ds_read_b64_tr_b16 v[164:165], v219 offset:0
    buffer_load_dwordx4 v14, s[4:7], s16 offen offset:0 lds
    v_mfma_f32_16x16x32_bf16 v[72:75], v[192:195], v[152:155], v[72:75]
    ds_read_b64_tr_b16 v[166:167], v219 offset:512
    v_mfma_f32_16x16x32_bf16 v[76:79], v[192:195], v[156:159], v[76:79]
    ds_read_b64_tr_b16 v[168:169], v218 offset:1024
    v_mfma_f32_16x16x32_bf16 v[80:83], v[196:199], v[144:147], v[80:83]
    buffer_load_dwordx4 v15, s[4:7], s16 offen offset:1024 lds
    v_mfma_f32_16x16x32_bf16 v[84:87], v[196:199], v[148:151], v[84:87]
    ds_read_b64_tr_b16 v[170:171], v218 offset:1536
    ds_read_b64_tr_b16 v[172:173], v219 offset:1024
    v_mfma_f32_16x16x32_bf16 v[88:91], v[196:199], v[152:155], v[88:91]
    ds_read_b64_tr_b16 v[174:175], v219 offset:1536
    v_mfma_f32_16x16x32_bf16 v[92:95], v[196:199], v[156:159], v[92:95]
    buffer_load_dwordx4 v16, s[4:7], s16 offen offset:2048 lds
    v_mfma_f32_16x16x32_bf16 v[96:99], v[144:147], v[200:203], v[96:99]
    ds_read_b64_tr_b16 v[176:177], v218 offset:2048
    ds_read_b64_tr_b16 v[178:179], v218 offset:2560
    v_mfma_f32_16x16x32_bf16 v[100:103], v[148:151], v[200:203], v[100:103]
    ds_read_b64_tr_b16 v[180:181], v219 offset:2048
    v_mfma_f32_16x16x32_bf16 v[104:107], v[152:155], v[200:203], v[104:107]
    buffer_load_dwordx4 v17, s[4:7], s16 offen offset:3072 lds
    v_mfma_f32_16x16x32_bf16 v[108:111], v[156:159], v[200:203], v[108:111]
    ds_read_b64_tr_b16 v[182:183], v219 offset:2560
    v_mfma_f32_16x16x32_bf16 v[112:115], v[144:147], v[204:207], v[112:115]
    v_mfma_f32_16x16x32_bf16 v[116:119], v[148:151], v[204:207], v[116:119]
    v_mfma_f32_16x16x32_bf16 v[120:123], v[152:155], v[204:207], v[120:123]
    v_mfma_f32_16x16x32_bf16 v[124:127], v[156:159], v[204:207], v[124:127]
sequential_preLN__softmax_full_mha__glu_gated_glu__prompt_kernel_phend1:
    s_waitcnt lgkmcnt(0)
    v_mfma_f32_16x16x32_bf16 v[32:35], v[160:163], v[128:131], v[32:35]
    ds_read_b128 v[144:147], v217 offset:0
    s_add_u32 m0, s19, 0
    v_mfma_f32_16x16x32_bf16 v[36:39], v[160:163], v[132:135], v[36:39]
    ds_read_b128 v[148:151], v217 offset:2048
    v_mfma_f32_16x16x32_bf16 v[40:43], v[160:163], v[136:139], v[40:43]
    s_add_u32 s17, s17, 393216
    ds_read_b128 v[152:155], v217 offset:4096
    v_mfma_f32_16x16x32_bf16 v[44:47], v[160:163], v[140:143], v[44:47]
    ds_read_b128 v[156:159], v217 offset:6144
    v_mfma_f32_16x16x32_bf16 v[48:51], v[164:167], v[128:131], v[48:51]
    s_cmp_eq_u32 s17, 6291456
    s_cselect_b32 s17, 0, s17
    v_mfma_f32_16x16x32_bf16 v[52:55], v[164:167], v[132:135], v[52:55]
    ds_read_b64_tr_b16 v[184:185], v218 offset:12288
    buffer_load_dwordx4 v8, s[8:11], s17 offen offset:0 lds
    v_mfma_f32_16x16x32_bf16 v[56:59], v[164:167], v[136:139], v[56:59]
    ds_read_b64_tr_b16 v[186:187], v218 offset:12800
    v_mfma_f32_16x16x32_bf16 v[60:63], v[164:167], v[140:143], v[60:63]
    ds_read_b64_tr_b16 v[188:189], v219 offset:12288
    v_mfma_f32_16x16x32_bf16 v[64:67], v[168:171], v[128:131], v[64:67]
    buffer_load_dwordx4 v9, s[8:11], s17 offen offset:1024 lds
    ds_read_b64_tr_b16 v[190:191], v219 offset:12800
    v_mfma_f32_16x16x32_bf16 v[68:71], v[168:171], v[132:135], v[68:71]
    buffer_load_dwordx4 v10, s[8:11], s17 offen offset:2048 lds
    v_mfma_f32_16x16x32_bf16 v[72:75], v[168:171], v[136:139], v[72:75]
    ds_read_b64_tr_b16 v[192:193], v218 offset:13312
    v_mfma_f32_16x16x32_bf16 v[76:79], v[168:171], v[140:143], v[76:79]
    buffer_load_dwordx4 v11, s[8:11], s17 offen offset:3072 lds
    ds_read_b64_tr_b16 v[194:195], v218 offset:13824
    v_mfma_f32_16x16x32_bf16 v[80:83], v[172:175], v[128:131], v[80:83]
    ds_read_b64_tr_b16 v[196:197], v219 offset:13312
    v_mfma_f32_16x16x32_bf16 v[84:87], v[172:175], v[132:135], v[84:87]
    s_add_u32 m0, s19, 4096
    v_mfma_f32_16x16x32_bf16 v[88:91], v[172:175], v[136:139], v[88:91]
    ds_read_b64_tr_b16 v[198:199], v219 offset:13824
    s_nop 0
    v_mfma_f32_16x16x32_bf16 v[92:95], v[172:175], v[140:143], v[92:95]
    ds_read_b64_tr_b16 v[200:201], v218 offset:14336
    v_mfma_f32_16x16x32_bf16 v[96:99], v[128:131], v[176:179], v[96:99]
    ds_read_b64_tr_b16 v[202:203], v218 offset:14848
    v_mfma_f32_16x16x32_bf16 v[100:103], v[132:135], v[176:179], v[100:103]
    buffer_load_dwordx4 v12, s[8:11], s17 offen offset:0 lds
    ds_read_b64_tr_b16 v[204:205], v219 offset:14336
    v_mfma_f32_16x16x32_bf16 v[104:107], v[136:139], v[176:179], v[104:107]
    buffer_load_dwordx4 v13, s[8:11], s17 offen offset:1024 lds
    v_mfma_f32_16x16x32_bf16 v[108:111], v[140:143], v[176:179], v[108:111]
    ds_read_b64_tr_b16 v[206:207], v219 offset:14848
    v_mfma_f32_16x16x32_bf16 v[112:115], v[128:131], v[180:183], v[112:115]
    v_mfma_f32_16x16x32_bf16 v[116:119], v[132:135], v[180:183], v[116:119]
    v_mfma_f32_16x16x32_bf16 v[120:123], v[136:139], v[180:183], v[120:123]
    v_mfma_f32_16x16x32_bf16 v[124:127], v[140:143], v[180:183], v[124:127]
    s_waitcnt lgkmcnt(0)
    v_mfma_f32_16x16x32_bf16 v[32:35], v[184:187], v[144:147], v[32:35]
    s_waitcnt vmcnt(10)
    s_barrier
    v_mfma_f32_16x16x32_bf16 v[36:39], v[184:187], v[148:151], v[36:39]
    s_cmp_eq_u32 s94, 2
    s_cbranch_scc1 sequential_preLN__softmax_full_mha__glu_gated_glu__prompt_kernel_sums
sequential_preLN__softmax_full_mha__glu_gated_glu__prompt_kernel_sumsr2:
    v_mfma_f32_16x16x32_bf16 v[40:43], v[184:187], v[152:155], v[40:43]
    s_cmp_eq_u32 s20, s93
    s_cbranch_scc1 sequential_preLN__softmax_full_mha__glu_gated_glu__prompt_kernel_signal
sequential_preLN__softmax_full_mha__glu_gated_glu__prompt_kernel_signalr2:
    v_mfma_f32_16x16x32_bf16 v[44:47], v[184:187], v[156:159], v[44:47]
    s_cmp_eq_u32 s20, 1
    s_cbranch_scc1 sequential_preLN__softmax_full_mha__glu_gated_glu__prompt_kernel_red1
sequential_preLN__softmax_full_mha__glu_gated_glu__prompt_kernel_red1r2:
    v_mfma_f32_16x16x32_bf16 v[48:51], v[188:191], v[144:147], v[48:51]
    ds_read_b128 v[128:131], v220 offset:0
    s_add_u32 m0, s18, 40960
    v_mfma_f32_16x16x32_bf16 v[52:55], v[188:191], v[148:151], v[52:55]
    ds_read_b128 v[132:135], v220 offset:2048
    v_mfma_f32_16x16x32_bf16 v[56:59], v[188:191], v[152:155], v[56:59]
    ds_read_b128 v[136:139], v220 offset:4096
    v_mfma_f32_16x16x32_bf16 v[60:63], v[188:191], v[156:159], v[60:63]
    ds_read_b128 v[140:143], v220 offset:6144
    s_add_u32 s16, s16, 128
    s_and_b32 s16, s16, 2047
    v_mfma_f32_16x16x32_bf16 v[64:67], v[192:195], v[144:147], v[64:67]
    ds_read_b64_tr_b16 v[160:161], v222 offset:0
    v_mfma_f32_16x16x32_bf16 v[68:71], v[192:195], v[148:151], v[68:71]
    ds_read_b64_tr_b16 v[162:163], v222 offset:512
    v_mfma_f32_16x16x32_bf16 v[72:75], v[192:195], v[152:155], v[72:75]
    ds_read_b64_tr_b16 v[164:165], v223 offset:0
    buffer_load_dwordx4 v14, s[4:7], s16 offen offset:0 lds
    v_mfma_f32_16x16x32_bf16 v[76:79], v[192:195], v[156:159], v[76:79]
    ds_read_b64_tr_b16 v[166:167], v223 offset:512
    v_mfma_f32_16x16x32_bf16 v[80:83], v[196:199], v[144:147], v[80:83]
    ds_read_b64_tr_b16 v[168:169], v222 offset:1024
    v_mfma_f32_16x16x32_bf16 v[84:87], v[196:199], v[148:151], v[84:87]
    buffer_load_dwordx4 v15, s[4:7], s16 offen offset:1024 lds
    v_mfma_f32_16x16x32_bf16 v[88:91], v[196:199], v[152:155], v[88:91]
    ds_read_b64_tr_b16 v[170:171], v222 offset:1536
    ds_read_b64_tr_b16 v[172:173], v223 offset:1024
    v_mfma_f32_16x16x32_bf16 v[92:95], v[196:199], v[156:159], v[92:95]
    ds_read_b64_tr_b16 v[174:175], v223 offset:1536
    v_mfma_f32_16x16x32_bf16 v[96:99], v[144:147], v[200:203], v[96:99]
    buffer_load_dwordx4 v16, s[4:7], s16 offen offset:2048 lds
    v_mfma_f32_16x16x32_bf16 v[100:103], v[148:151], v[200:203], v[100:103]
    ds_read_b64_tr_b16 v[176:177], v222 offset:2048
    ds_read_b64_tr_b16 v[178:179], v222 offset:2560
    v_mfma_f32_16x16x32_bf16 v[104:107], v[152:155], v[200:203], v[104:107]
    ds_read_b64_tr_b16 v[180:181], v223 offset:2048
    v_mfma_f32_16x16x32_bf16 v[108:111], v[156:159], v[200:203], v[108:111]
    buffer_load_dwordx4 v17, s[4:7], s16 offen offset:3072 lds
    v_mfma_f32_16x16x32_bf16 v[112:115], v[144:147], v[204:207], v[112:115]
    ds_read_b64_tr_b16 v[182:183], v223 offset:2560
    v_mfma_f32_16x16x32_bf16 v[116:119], v[148:151], v[204:207], v[116:119]
    v_mfma_f32_16x16x32_bf16 v[120:123], v[152:155], v[204:207], v[120:123]
    v_mfma_f32_16x16x32_bf16 v[124:127], v[156:159], v[204:207], v[124:127]
sequential_preLN__softmax_full_mha__glu_gated_glu__prompt_kernel_phend2:
    s_waitcnt lgkmcnt(0)
    v_mfma_f32_16x16x32_bf16 v[32:35], v[160:163], v[128:131], v[32:35]
    ds_read_b128 v[144:147], v221 offset:0
    s_add_u32 m0, s19, 40960
    v_mfma_f32_16x16x32_bf16 v[36:39], v[160:163], v[132:135], v[36:39]
    ds_read_b128 v[148:151], v221 offset:2048
    v_mfma_f32_16x16x32_bf16 v[40:43], v[160:163], v[136:139], v[40:43]
    s_add_u32 s17, s17, 393216
    ds_read_b128 v[152:155], v221 offset:4096
    v_mfma_f32_16x16x32_bf16 v[44:47], v[160:163], v[140:143], v[44:47]
    ds_read_b128 v[156:159], v221 offset:6144
    v_mfma_f32_16x16x32_bf16 v[48:51], v[164:167], v[128:131], v[48:51]
    s_cmp_eq_u32 s17, 6291456
    s_cselect_b32 s17, 0, s17
    v_mfma_f32_16x16x32_bf16 v[52:55], v[164:167], v[132:135], v[52:55]
    ds_read_b64_tr_b16 v[184:185], v222 offset:12288
    buffer_load_dwordx4 v8, s[8:11], s17 offen offset:0 lds
    v_mfma_f32_16x16x32_bf16 v[56:59], v[164:167], v[136:139], v[56:59]
    ds_read_b64_tr_b16 v[186:187], v222 offset:12800
    v_mfma_f32_16x16x32_bf16 v[60:63], v[164:167], v[140:143], v[60:63]
    ds_read_b64_tr_b16 v[188:189], v223 offset:12288
    v_mfma_f32_16x16x32_bf16 v[64:67], v[168:171], v[128:131], v[64:67]
    buffer_load_dwordx4 v9, s[8:11], s17 offen offset:1024 lds
    ds_read_b64_tr_b16 v[190:191], v223 offset:12800
    v_mfma_f32_16x16x32_bf16 v[68:71], v[168:171], v[132:135], v[68:71]
    buffer_load_dwordx4 v10, s[8:11], s17 offen offset:2048 lds
    v_mfma_f32_16x16x32_bf16 v[72:75], v[168:171], v[136:139], v[72:75]
    ds_read_b64_tr_b16 v[192:193], v222 offset:13312
    v_mfma_f32_16x16x32_bf16 v[76:79], v[168:171], v[140:143], v[76:79]
    buffer_load_dwordx4 v11, s[8:11], s17 offen offset:3072 lds
    ds_read_b64_tr_b16 v[194:195], v222 offset:13824
    v_mfma_f32_16x16x32_bf16 v[80:83], v[172:175], v[128:131], v[80:83]
    ds_read_b64_tr_b16 v[196:197], v223 offset:13312
    v_mfma_f32_16x16x32_bf16 v[84:87], v[172:175], v[132:135], v[84:87]
    s_add_u32 m0, s19, 45056
    v_mfma_f32_16x16x32_bf16 v[88:91], v[172:175], v[136:139], v[88:91]
    ds_read_b64_tr_b16 v[198:199], v223 offset:13824
    s_nop 0
    v_mfma_f32_16x16x32_bf16 v[92:95], v[172:175], v[140:143], v[92:95]
    ds_read_b64_tr_b16 v[200:201], v222 offset:14336
    v_mfma_f32_16x16x32_bf16 v[96:99], v[128:131], v[176:179], v[96:99]
    ds_read_b64_tr_b16 v[202:203], v222 offset:14848
    v_mfma_f32_16x16x32_bf16 v[100:103], v[132:135], v[176:179], v[100:103]
    buffer_load_dwordx4 v12, s[8:11], s17 offen offset:0 lds
    ds_read_b64_tr_b16 v[204:205], v223 offset:14336
    v_mfma_f32_16x16x32_bf16 v[104:107], v[136:139], v[176:179], v[104:107]
    buffer_load_dwordx4 v13, s[8:11], s17 offen offset:1024 lds
    v_mfma_f32_16x16x32_bf16 v[108:111], v[140:143], v[176:179], v[108:111]
    ds_read_b64_tr_b16 v[206:207], v223 offset:14848
    v_mfma_f32_16x16x32_bf16 v[112:115], v[128:131], v[180:183], v[112:115]
    v_mfma_f32_16x16x32_bf16 v[116:119], v[132:135], v[180:183], v[116:119]
    v_mfma_f32_16x16x32_bf16 v[120:123], v[136:139], v[180:183], v[120:123]
    v_mfma_f32_16x16x32_bf16 v[124:127], v[140:143], v[180:183], v[124:127]
    s_waitcnt lgkmcnt(0)
    v_mfma_f32_16x16x32_bf16 v[32:35], v[184:187], v[144:147], v[32:35]
    s_cmp_eq_u32 s20, s93
    s_cselect_b32 s93, 2, s93
    s_cbranch_scc1 sequential_preLN__softmax_full_mha__glu_gated_glu__prompt_kernel_alt31
    s_waitcnt vmcnt(10)
sequential_preLN__softmax_full_mha__glu_gated_glu__prompt_kernel_alt31:
    s_waitcnt vmcnt(11)
    s_barrier
    v_mfma_f32_16x16x32_bf16 v[36:39], v[184:187], v[148:151], v[36:39]
    s_cmp_eq_u32 s94, 3
    s_cbranch_scc1 sequential_preLN__softmax_full_mha__glu_gated_glu__prompt_kernel_sums
sequential_preLN__softmax_full_mha__glu_gated_glu__prompt_kernel_sumsr3:
    v_mfma_f32_16x16x32_bf16 v[40:43], v[184:187], v[152:155], v[40:43]
    s_cmp_eq_u32 s20, 1
    s_cbranch_scc1 sequential_preLN__softmax_full_mha__glu_gated_glu__prompt_kernel_red2
sequential_preLN__softmax_full_mha__glu_gated_glu__prompt_kernel_red2r3:
    v_mfma_f32_16x16x32_bf16 v[44:47], v[184:187], v[156:159], v[44:47]
    ds_read_b128 v[128:131], v208 offset:0
    s_add_u32 m0, s18, 81920
    v_mfma_f32_16x16x32_bf16 v[48:51], v[188:191], v[144:147], v[48:51]
    ds_read_b128 v[132:135], v208 offset:2048
    v_mfma_f32_16x16x32_bf16 v[52:55], v[188:191], v[148:151], v[52:55]
    ds_read_b128 v[136:139], v208 offset:4096
    v_mfma_f32_16x16x32_bf16 v[56:59], v[188:191], v[152:155], v[56:59]
    ds_read_b128 v[140:143], v208 offset:6144
    s_add_u32 s16, s16, 128
    s_and_b32 s16, s16, 2047
    v_mfma_f32_16x16x32_bf16 v[60:63], v[188:191], v[156:159], v[60:63]
    ds_read_b64_tr_b16 v[160:161], v210 offset:0
    v_mfma_f32_16x16x32_bf16 v[64:67], v[192:195], v[144:147], v[64:67]
    ds_read_b64_tr_b16 v[162:163], v210 offset:512
    v_mfma_f32_16x16x32_bf16 v[68:71], v[192:195], v[148:151], v[68:71]
    ds_read_b64_tr_b16 v[164:165], v211 offset:0
    buffer_load_dwordx4 v14, s[4:7], s16 offen offset:0 lds
    v_mfma_f32_16x16x32_bf16 v[72:75], v[192:195], v[152:155], v[72:75]
    ds_read_b64_tr_b16 v[166:167], v211 offset:512
    v_mfma_f32_16x16x32_bf16 v[76:79], v[192:195], v[156:159], v[76:79]
    ds_read_b64_tr_b16 v[168:169], v210 offset:1024
    v_mfma_f32_16x16x32_bf16 v[80:83], v[196:199], v[144:147], v[80:83]
    buffer_load_dwordx4 v15, s[4:7], s16 offen offset:1024 lds
    v_mfma_f32_16x16x32_bf16 v[84:87], v[196:199], v[148:151], v[84:87]
    ds_read_b64_tr_b16 v[170:171], v210 offset:1536
    ds_read_b64_tr_b16 v[172:173], v211 offset:1024
    v_mfma_f32_16x16x32_bf16 v[88:91], v[196:199], v[152:155], v[88:91]
    ds_read_b64_tr_b16 v[174:175], v211 offset:1536
    v_mfma_f32_16x16x32_bf16 v[92:95], v[196:199], v[156:159], v[92:95]
    buffer_load_dwordx4 v16, s[4:7], s16 offen offset:2048 lds
    v_mfma_f32_16x16x32_bf16 v[96:99], v[144:147], v[200:203], v[96:99]
    ds_read_b64_tr_b16 v[176:177], v210 offset:2048
    ds_read_b64_tr_b16 v[178:179], v210 offset:2560
    v_mfma_f32_16x16x32_bf16 v[100:103], v[148:151], v[200:203], v[100:103]
    ds_read_b64_tr_b16 v[180:181], v211 offset:2048
    v_mfma_f32_16x16x32_bf16 v[104:107], v[152:155], v[200:203], v[104:107]
    buffer_load_dwordx4 v17, s[4:7], s16 offen offset:3072 lds
    v_mfma_f32_16x16x32_bf16 v[108:111], v[156:159], v[200:203], v[108:111]
    ds_read_b64_tr_b16 v[182:183], v211 offset:2560
    v_mfma_f32_16x16x32_bf16 v[112:115], v[144:147], v[204:207], v[112:115]
    v_mfma_f32_16x16x32_bf16 v[116:119], v[148:151], v[204:207], v[116:119]
    s_sub_u32 s20, s20, 1
    v_mfma_f32_16x16x32_bf16 v[120:123], v[152:155], v[204:207], v[120:123]
    s_cmp_lg_u32 s20, 0
    v_mfma_f32_16x16x32_bf16 v[124:127], v[156:159], v[204:207], v[124:127]
sequential_preLN__softmax_full_mha__glu_gated_glu__prompt_kernel_phend3:
    s_waitcnt lgkmcnt(0)
    s_cbranch_scc1 sequential_preLN__softmax_full_mha__glu_gated_glu__prompt_kernel_p1loop
    s_waitcnt vmcnt(0)
    s_barrier
    s_nop 5
    ds_read_b128 v[128:131], v22 offset:0
    ds_read_b128 v[132:135], v22 offset:64
    ds_read_b128 v[136:139], v22 offset:256
    ds_read_b128 v[140:143], v22 offset:320
    ds_read_b32 v144, v24 offset:1024
    ds_read_b32 v148, v24 offset:1536
    ds_read_b32 v145, v24 offset:1088
    ds_read_b32 v149, v24 offset:1600
    ds_read_b32 v146, v24 offset:1152
    ds_read_b32 v150, v24 offset:1664
    ds_read_b32 v147, v24 offset:1216
    ds_read_b32 v151, v24 offset:1728
    s_waitcnt lgkmcnt(0)
    ds_read_b32 v152, v23 offset:512
    ds_read_b32 v153, v23 offset:576
    ds_read_b128 v[160:163], v25 offset:1024
    ds_read_b128 v[164:167], v25 offset:1536
    ds_read_b128 v[168:171], v25 offset:1088
    ds_read_b128 v[172:175], v25 offset:1600
    ds_read_b128 v[176:179], v25 offset:1152
    ds_read_b128 v[180:183], v25 offset:1664
    ds_read_b128 v[184:187], v25 offset:1216
    ds_read_b128 v[188:191], v25 offset:1728
    v_mul_f32 v192, 0x3e8293ee, v148
    v_mul_f32 v193, 0x3e8293ee, v149
    v_mul_f32 v194, 0x3e8293ee, v150
    v_mul_f32 v195, 0x3e8293ee, v151
    v_pk_fma_f32 v[64:65], v[136:137], v[144:145], v[64:65] op_sel:[0,0,0] op_sel_hi:[1,0,1]
    v_pk_fma_f32 v[66:67], v[138:139], v[144:145], v[66:67] op_sel:[0,0,0] op_sel_hi:[1,0,1]
    v_pk_fma_f32 v[68:69], v[136:137], v[144:145], v[68:69] op_sel:[0,1,0] op_sel_hi:[1,1,1]
    v_pk_fma_f32 v[70:71], v[138:139], v[144:145], v[70:71] op_sel:[0,1,0] op_sel_hi:[1,1,1]
    v_pk_fma_f32 v[72:73], v[136:137], v[146:147], v[72:73] op_sel:[0,0,0] op_sel_hi:[1,0,1]
    v_pk_fma_f32 v[74:75], v[138:139], v[146:147], v[74:75] op_sel:[0,0,0] op_sel_hi:[1,0,1]
    v_pk_fma_f32 v[76:77], v[136:137], v[146:147], v[76:77] op_sel:[0,1,0] op_sel_hi:[1,1,1]
    v_pk_fma_f32 v[78:79], v[138:139], v[146:147], v[78:79] op_sel:[0,1,0] op_sel_hi:[1,1,1]
    v_pk_mul_f32 v[64:65], v[64:65], v[148:149] op_sel:[0,0] op_sel_hi:[1,0]
    v_pk_mul_f32 v[66:67], v[66:67], v[148:149] op_sel:[0,0] op_sel_hi:[1,0]
    v_pk_mul_f32 v[68:69], v[68:69], v[148:149] op_sel:[0,1] op_sel_hi:[1,1]
    v_pk_mul_f32 v[70:71], v[70:71], v[148:149] op_sel:[0,1] op_sel_hi:[1,1]
    v_pk_mul_f32 v[72:73], v[72:73], v[150:151] op_sel:[0,0] op_sel_hi:[1,0]
    v_pk_mul_f32 v[74:75], v[74:75], v[150:151] op_sel:[0,0] op_sel_hi:[1,0]
    v_pk_mul_f32 v[76:77], v[76:77], v[150:151] op_sel:[0,1] op_sel_hi:[1,1]
    v_pk_mul_f32 v[78:79], v[78:79], v[150:151] op_sel:[0,1] op_sel_hi:[1,1]
    v_pk_fma_f32 v[80:81], v[140:141], v[144:145], v[80:81] op_sel:[0,0,0] op_sel_hi:[1,0,1]
    v_pk_fma_f32 v[82:83], v[142:143], v[144:145], v[82:83] op_sel:[0,0,0] op_sel_hi:[1,0,1]
    v_pk_fma_f32 v[84:85], v[140:141], v[144:145], v[84:85] op_sel:[0,1,0] op_sel_hi:[1,1,1]
    v_pk_fma_f32 v[86:87], v[142:143], v[144:145], v[86:87] op_sel:[0,1,0] op_sel_hi:[1,1,1]
    v_pk_fma_f32 v[88:89], v[140:141], v[146:147], v[88:89] op_sel:[0,0,0] op_sel_hi:[1,0,1]
    v_pk_fma_f32 v[90:91], v[142:143], v[146:147], v[90:91] op_sel:[0,0,0] op_sel_hi:[1,0,1]
    v_pk_fma_f32 v[92:93], v[140:141], v[146:147], v[92:93] op_sel:[0,1,0] op_sel_hi:[1,1,1]
    v_pk_fma_f32 v[94:95], v[142:143], v[146:147], v[94:95] op_sel:[0,1,0] op_sel_hi:[1,1,1]
    v_pk_mul_f32 v[80:81], v[80:81], v[148:149] op_sel:[0,0] op_sel_hi:[1,0]
    v_pk_mul_f32 v[82:83], v[82:83], v[148:149] op_sel:[0,0] op_sel_hi:[1,0]
    v_pk_mul_f32 v[84:85], v[84:85], v[148:149] op_sel:[0,1] op_sel_hi:[1,1]
    v_pk_mul_f32 v[86:87], v[86:87], v[148:149] op_sel:[0,1] op_sel_hi:[1,1]
    v_pk_mul_f32 v[88:89], v[88:89], v[150:151] op_sel:[0,0] op_sel_hi:[1,0]
    v_pk_mul_f32 v[90:91], v[90:91], v[150:151] op_sel:[0,0] op_sel_hi:[1,0]
    v_pk_mul_f32 v[92:93], v[92:93], v[150:151] op_sel:[0,1] op_sel_hi:[1,1]
    v_pk_mul_f32 v[94:95], v[94:95], v[150:151] op_sel:[0,1] op_sel_hi:[1,1]
    v_pk_fma_f32 v[32:33], v[128:129], v[144:145], v[32:33] op_sel:[0,0,0] op_sel_hi:[1,0,1]
    v_pk_fma_f32 v[34:35], v[130:131], v[144:145], v[34:35] op_sel:[0,0,0] op_sel_hi:[1,0,1]
    v_pk_fma_f32 v[36:37], v[128:129], v[144:145], v[36:37] op_sel:[0,1,0] op_sel_hi:[1,1,1]
    v_pk_fma_f32 v[38:39], v[130:131], v[144:145], v[38:39] op_sel:[0,1,0] op_sel_hi:[1,1,1]
    v_pk_fma_f32 v[40:41], v[128:129], v[146:147], v[40:41] op_sel:[0,0,0] op_sel_hi:[1,0,1]
    v_pk_fma_f32 v[42:43], v[130:131], v[146:147], v[42:43] op_sel:[0,0,0] op_sel_hi:[1,0,1]
    v_pk_fma_f32 v[44:45], v[128:129], v[146:147], v[44:45] op_sel:[0,1,0] op_sel_hi:[1,1,1]
    v_pk_fma_f32 v[46:47], v[130:131], v[146:147], v[46:47] op_sel:[0,1,0] op_sel_hi:[1,1,1]
    v_pk_mul_f32 v[32:33], v[32:33], v[192:193] op_sel:[0,0] op_sel_hi:[1,0]
    v_pk_mul_f32 v[34:35], v[34:35], v[192:193] op_sel:[0,0] op_sel_hi:[1,0]
    v_pk_mul_f32 v[36:37], v[36:37], v[192:193] op_sel:[0,1] op_sel_hi:[1,1]
    v_pk_mul_f32 v[38:39], v[38:39], v[192:193] op_sel:[0,1] op_sel_hi:[1,1]
    v_pk_mul_f32 v[40:41], v[40:41], v[194:195] op_sel:[0,0] op_sel_hi:[1,0]
    v_pk_mul_f32 v[42:43], v[42:43], v[194:195] op_sel:[0,0] op_sel_hi:[1,0]
    v_pk_mul_f32 v[44:45], v[44:45], v[194:195] op_sel:[0,1] op_sel_hi:[1,1]
    v_pk_mul_f32 v[46:47], v[46:47], v[194:195] op_sel:[0,1] op_sel_hi:[1,1]
    v_pk_fma_f32 v[48:49], v[132:133], v[144:145], v[48:49] op_sel:[0,0,0] op_sel_hi:[1,0,1]
    v_pk_fma_f32 v[50:51], v[134:135], v[144:145], v[50:51] op_sel:[0,0,0] op_sel_hi:[1,0,1]
    v_pk_fma_f32 v[52:53], v[132:133], v[144:145], v[52:53] op_sel:[0,1,0] op_sel_hi:[1,1,1]
    v_pk_fma_f32 v[54:55], v[134:135], v[144:145], v[54:55] op_sel:[0,1,0] op_sel_hi:[1,1,1]
    v_pk_fma_f32 v[56:57], v[132:133], v[146:147], v[56:57] op_sel:[0,0,0] op_sel_hi:[1,0,1]
    v_pk_fma_f32 v[58:59], v[134:135], v[146:147], v[58:59] op_sel:[0,0,0] op_sel_hi:[1,0,1]
    v_pk_fma_f32 v[60:61], v[132:133], v[146:147], v[60:61] op_sel:[0,1,0] op_sel_hi:[1,1,1]
    v_pk_fma_f32 v[62:63], v[134:135], v[146:147], v[62:63] op_sel:[0,1,0] op_sel_hi:[1,1,1]
    v_pk_mul_f32 v[48:49], v[48:49], v[192:193] op_sel:[0,0] op_sel_hi:[1,0]
    v_pk_mul_f32 v[50:51], v[50:51], v[192:193] op_sel:[0,0] op_sel_hi:[1,0]
    v_pk_mul_f32 v[52:53], v[52:53], v[192:193] op_sel:[0,1] op_sel_hi:[1,1]
    v_pk_mul_f32 v[54:55], v[54:55], v[192:193] op_sel:[0,1] op_sel_hi:[1,1]
    v_pk_mul_f32 v[56:57], v[56:57], v[194:195] op_sel:[0,0] op_sel_hi:[1,0]
    v_pk_mul_f32 v[58:59], v[58:59], v[194:195] op_sel:[0,0] op_sel_hi:[1,0]
    v_pk_mul_f32 v[60:61], v[60:61], v[194:195] op_sel:[0,1] op_sel_hi:[1,1]
    v_pk_mul_f32 v[62:63], v[62:63], v[194:195] op_sel:[0,1] op_sel_hi:[1,1]
    s_waitcnt lgkmcnt(0)
    v_pk_fma_f32 v[96:97], v[160:161], v[152:153], v[96:97] op_sel:[0,0,0] op_sel_hi:[1,0,1]
    v_pk_fma_f32 v[98:99], v[162:163], v[152:153], v[98:99] op_sel:[0,0,0] op_sel_hi:[1,0,1]
    v_pk_fma_f32 v[100:101], v[168:169], v[152:153], v[100:101] op_sel:[0,0,0] op_sel_hi:[1,0,1]
    v_pk_fma_f32 v[102:103], v[170:171], v[152:153], v[102:103] op_sel:[0,0,0] op_sel_hi:[1,0,1]
    v_pk_fma_f32 v[104:105], v[176:177], v[152:153], v[104:105] op_sel:[0,0,0] op_sel_hi:[1,0,1]
    v_pk_fma_f32 v[106:107], v[178:179], v[152:153], v[106:107] op_sel:[0,0,0] op_sel_hi:[1,0,1]
    v_pk_fma_f32 v[108:109], v[184:185], v[152:153], v[108:109] op_sel:[0,0,0] op_sel_hi:[1,0,1]
    v_pk_fma_f32 v[110:111], v[186:187], v[152:153], v[110:111] op_sel:[0,0,0] op_sel_hi:[1,0,1]
    v_pk_mul_f32 v[96:97], v[96:97], v[164:165] op_sel:[0,0] op_sel_hi:[1,1]
    v_pk_mul_f32 v[98:99], v[98:99], v[166:167] op_sel:[0,0] op_sel_hi:[1,1]
    v_pk_mul_f32 v[100:101], v[100:101], v[172:173] op_sel:[0,0] op_sel_hi:[1,1]
    v_pk_mul_f32 v[102:103], v[102:103], v[174:175] op_sel:[0,0] op_sel_hi:[1,1]
    v_pk_mul_f32 v[104:105], v[104:105], v[180:181] op_sel:[0,0] op_sel_hi:[1,1]
    v_pk_mul_f32 v[106:107], v[106:107], v[182:183] op_sel:[0,0] op_sel_hi:[1,1]
    v_pk_mul_f32 v[108:109], v[108:109], v[188:189] op_sel:[0,0] op_sel_hi:[1,1]
    v_pk_mul_f32 v[110:111], v[110:111], v[190:191] op_sel:[0,0] op_sel_hi:[1,1]
    v_pk_fma_f32 v[112:113], v[160:161], v[152:153], v[112:113] op_sel:[0,1,0] op_sel_hi:[1,1,1]
    v_pk_fma_f32 v[114:115], v[162:163], v[152:153], v[114:115] op_sel:[0,1,0] op_sel_hi:[1,1,1]
    v_pk_fma_f32 v[116:117], v[168:169], v[152:153], v[116:117] op_sel:[0,1,0] op_sel_hi:[1,1,1]
    v_pk_fma_f32 v[118:119], v[170:171], v[152:153], v[118:119] op_sel:[0,1,0] op_sel_hi:[1,1,1]
    v_pk_fma_f32 v[120:121], v[176:177], v[152:153], v[120:121] op_sel:[0,1,0] op_sel_hi:[1,1,1]
    v_pk_fma_f32 v[122:123], v[178:179], v[152:153], v[122:123] op_sel:[0,1,0] op_sel_hi:[1,1,1]
    v_pk_fma_f32 v[124:125], v[184:185], v[152:153], v[124:125] op_sel:[0,1,0] op_sel_hi:[1,1,1]
    v_pk_fma_f32 v[126:127], v[186:187], v[152:153], v[126:127] op_sel:[0,1,0] op_sel_hi:[1,1,1]
    v_pk_mul_f32 v[112:113], v[112:113], v[164:165] op_sel:[0,0] op_sel_hi:[1,1]
    v_pk_mul_f32 v[114:115], v[114:115], v[166:167] op_sel:[0,0] op_sel_hi:[1,1]
    v_pk_mul_f32 v[116:117], v[116:117], v[172:173] op_sel:[0,0] op_sel_hi:[1,1]
    v_pk_mul_f32 v[118:119], v[118:119], v[174:175] op_sel:[0,0] op_sel_hi:[1,1]
    v_pk_mul_f32 v[120:121], v[120:121], v[180:181] op_sel:[0,0] op_sel_hi:[1,1]
    v_pk_mul_f32 v[122:123], v[122:123], v[182:183] op_sel:[0,0] op_sel_hi:[1,1]
    v_pk_mul_f32 v[124:125], v[124:125], v[188:189] op_sel:[0,0] op_sel_hi:[1,1]
    v_pk_mul_f32 v[126:127], v[126:127], v[190:191] op_sel:[0,0] op_sel_hi:[1,1]
    s_lshl_b32 s45, s41, 1
    s_add_u32 s45, s45, s44
    s_lshl_b32 s46, s40, 2
    s_lshl_b32 s47, s43, 1
    s_add_u32 s46, s46, s47
    s_lshl_b32 s45, s45, 6
    s_add_u32 s45, s45, s46
    s_lshl_b32 s46, s45, 11
    s_lshl_b32 s47, s45, 12
    s_add_u32 s47, s47, 4194304
    s_mov_b32 s48, 0x3e8293ee
    v_lshlrev_b32 v10, 9, v2
    v_lshl_add_u32 v11, v3, 4, v10
    v_and_b32 v12, 7, v3
    v_lshlrev_b32 v12, 4, v12
    v_and_b32 v13, 8, v3
    v_lshl_add_u32 v12, v13, 5, v12
    v_add_u32 v12, v12, v10
    v_cvt_pk_bf16_f32 v128, v32, v33
    v_cvt_pk_bf16_f32 v129, v34, v35
    v_cvt_pk_bf16_f32 v130, v48, v49
    v_cvt_pk_bf16_f32 v131, v50, v51
    buffer_store_dwordx4 v[128:131], v11, s[12:15], s46 offen offset:0 sc1
    v_cvt_pk_bf16_f32 v132, v36, v37
    v_cvt_pk_bf16_f32 v133, v38, v39
    v_cvt_pk_bf16_f32 v134, v52, v53
    v_cvt_pk_bf16_f32 v135, v54, v55
    buffer_store_dwordx4 v[132:135], v11, s[12:15], s46 offen offset:256 sc1
    v_cvt_pk_bf16_f32 v136, v40, v41
    v_cvt_pk_bf16_f32 v137, v42, v43
    v_cvt_pk_bf16_f32 v138, v56, v57
    v_cvt_pk_bf16_f32 v139, v58, v59
    buffer_store_dwordx4 v[136:139], v11, s[12:15], s46 offen offset:2048 sc1
    v_cvt_pk_bf16_f32 v140, v44, v45
    v_cvt_pk_bf16_f32 v141, v46, v47
    v_cvt_pk_bf16_f32 v142, v60, v61
    v_cvt_pk_bf16_f32 v143, v62, v63
    buffer_store_dwordx4 v[140:143], v11, s[12:15], s46 offen offset:2304 sc1
    s_add_u32 s49, s47, 4096
    v_cvt_pk_bf16_f32 v144, v64, v65
    v_cvt_pk_bf16_f32 v145, v66, v67
    v_cvt_pk_bf16_f32 v146, v80, v81
    v_cvt_pk_bf16_f32 v147, v82, v83
    buffer_store_dwordx4 v[144:147], v12, s[12:15], s47 offen offset:0 sc1
    v_cvt_pk_bf16_f32 v148, v68, v69
    v_cvt_pk_bf16_f32 v149, v70, v71
    v_cvt_pk_bf16_f32 v150, v84, v85
    v_cvt_pk_bf16_f32 v151, v86, v87
    buffer_store_dwordx4 v[148:151], v12, s[12:15], s47 offen offset:128 sc1
    v_cvt_pk_bf16_f32 v152, v72, v73
    v_cvt_pk_bf16_f32 v153, v74, v75
    v_cvt_pk_bf16_f32 v154, v88, v89
    v_cvt_pk_bf16_f32 v155, v90, v91
    buffer_store_dwordx4 v[152:155], v12, s[12:15], s49 offen offset:0 sc1
    v_cvt_pk_bf16_f32 v156, v76, v77
    v_cvt_pk_bf16_f32 v157, v78, v79
    v_cvt_pk_bf16_f32 v158, v92, v93
    v_cvt_pk_bf16_f32 v159, v94, v95
    buffer_store_dwordx4 v[156:159], v12, s[12:15], s49 offen offset:128 sc1
    v_cvt_pk_bf16_f32 v160, v96, v97
    v_cvt_pk_bf16_f32 v161, v98, v99
    v_cvt_pk_bf16_f32 v162, v100, v101
    v_cvt_pk_bf16_f32 v163, v102, v103
    buffer_store_dwordx4 v[160:163], v11, s[12:15], s47 offen offset:2048 sc1
    v_cvt_pk_bf16_f32 v164, v104, v105
    v_cvt_pk_bf16_f32 v165, v106, v107
    v_cvt_pk_bf16_f32 v166, v108, v109
    v_cvt_pk_bf16_f32 v167, v110, v111
    buffer_store_dwordx4 v[164:167], v11, s[12:15], s49 offen offset:2048 sc1
    v_cvt_pk_bf16_f32 v168, v112, v113
    v_cvt_pk_bf16_f32 v169, v114, v115
    v_cvt_pk_bf16_f32 v170, v116, v117
    v_cvt_pk_bf16_f32 v171, v118, v119
    buffer_store_dwordx4 v[168:171], v11, s[12:15], s47 offen offset:2304 sc1
    v_cvt_pk_bf16_f32 v172, v120, v121
    v_cvt_pk_bf16_f32 v173, v122, v123
    v_cvt_pk_bf16_f32 v174, v124, v125
    v_cvt_pk_bf16_f32 v175, v126, v127
    buffer_store_dwordx4 v[172:175], v11, s[12:15], s49 offen offset:2304 sc1
    s_add_u32 s92, s41, 16
    s_lshl_b32 s40, s38, 2
    s_lshr_b32 s45, s39, 3
    s_add_u32 s40, s40, s45
    s_and_b32 s41, s39, 7
    v_lshlrev_b32 v4, 4, v1
    s_lshl_b32 s31, s40, 18
    s_lshl_b32 s16, s42, 12
    s_mov_b32 s18, s16
    s_lshl_b32 s45, s40, 6
    s_lshl_b32 s46, s41, 3
    s_add_u32 s45, s45, s46
    s_lshl_b32 s46, s42, 1
    s_add_u32 s45, s45, s46
    s_lshl_b32 s17, s45, 11
    s_add_u32 s4, s82, 8388608
    s_addc_u32 s5, s83, 0
    s_and_b32 s5, s5, 0xffff
    s_mov_b32 s6, 262144
    s_mov_b32 s7, 0x20000
    s_add_u32 s4, s4, s31
    s_addc_u32 s5, s5, 0
    s_add_u32 s8, s82, 4194304
    s_addc_u32 s9, s83, 0
    s_and_b32 s9, s9, 0xffff
    s_mov_b32 s10, 4194304
    s_mov_b32 s11, 0x20000
    s_waitcnt vmcnt(0)
    s_barrier
    s_cmp_lg_u32 s42, 0
    s_cbranch_scc1 sequential_preLN__softmax_full_mha__glu_gated_glu__prompt_kernel_b3a
    s_lshl_b32 s92, s92, 8
    v_mov_b32 v30, s92
    v_mov_b32 v31, 1
    s_mov_b64 exec, 1
    buffer_atomic_add v31, v30, s[84:87], 0 offen sc1
    s_mov_b64 exec, -1
sequential_preLN__softmax_full_mha__glu_gated_glu__prompt_kernel_b3a:
    s_lshl_b32 s47, s2, 2
    s_add_u32 s47, s47, s42
    s_lshr_b32 s48, s47, 3
    s_and_b32 s49, s47, 7
    s_mul_i32 s21, s49, 917504
    s_cmp_ge_u32 s48, 56
    s_cselect_b32 s45, 56, 0
    s_cselect_b32 s34, s74, s72
    s_cselect_b32 s35, s75, s73
    s_sub_u32 s45, s48, s45
    s_lshl_b32 s45, s45, 7
    s_add_u32 s21, s21, s45
    s_sub_u32 s21, s21, 57344
    v_lshrrev_b32 v2, 3, v1
    v_and_b32 v3, 7, v1
    v_mul_u32_u24 v2, 7168, v2
    v_lshl_add_u32 v7, v3, 4, v2
    s_mul_i32 s19, s42, 17408
    s_add_u32 s19, s19, 65536
    s_mul_i32 s30, s47, 7168
    s_mov_b32 s22, 0
    s_add_u32 s12, s82, 16777216
    s_addc_u32 s13, s83, 0
    s_and_b32 s13, s13, 0xffff
    s_mov_b32 s14, 4194304
    s_mov_b32 s15, 0x20000
    s_mov_b32 s52, s34
    s_and_b32 s53, s35, 0xffff
    s_mov_b32 s54, 7340032
    s_mov_b32 s55, 0x20000
    s_cmp_ge_u32 s48, 112
    s_cselect_b32 s54, 0, s54
    s_mov_b32 s56, s76
    s_and_b32 s57, s77, 0xffff
    s_mov_b32 s58, 7168
    s_mov_b32 s59, 0x20000
    s_add_u32 s56, s56, s30
    s_addc_u32 s57, s57, 0
    v_lshrrev_b32 v2, 4, v1
    v_lshrrev_b32 v3, 2, v1
    v_xor_b32 v2, v2, v3
    v_and_b32 v2, 1, v2
    v_mov_b32 v3, 0x3f803f80
    v_cmp_eq_u32 vcc, 0, v2
    v_mov_b32 v5, v4
    v_mov_b32 v6, v4
    v_cndmask_b32 v144, 0, v3, vcc
    v_mov_b32 v145, v144
    v_mov_b32 v146, v144
    v_mov_b32 v147, v144
    v_mov_b32 v104, 0
    v_mov_b32 v105, 0
    v_mov_b32 v106, 0
    v_mov_b32 v107, 0
    v_mov_b32 v108, 0
    v_mov_b32 v109, 0
    v_mov_b32 v110, 0
    v_mov_b32 v111, 0
    v_mov_b32 v112, 0
    v_mov_b32 v113, 0
    v_mov_b32 v114, 0
    v_mov_b32 v115, 0
    v_mov_b32 v116, 0
    v_mov_b32 v117, 0
    v_mov_b32 v118, 0
    v_mov_b32 v119, 0
    v_mov_b32 v120, 0
    v_mov_b32 v121, 0
    v_mov_b32 v122, 0
    v_mov_b32 v123, 0
    v_mov_b32 v124, 0
    v_mov_b32 v125, 0
    v_mov_b32 v126, 0
    v_mov_b32 v127, 0
    v_mov_b32 v128, 0
    v_mov_b32 v129, 0
    v_mov_b32 v130, 0
    v_mov_b32 v131, 0
    v_mov_b32 v132, 0
    v_mov_b32 v133, 0
    v_mov_b32 v134, 0
    v_mov_b32 v135, 0
    v_mov_b32 v136, 0
    v_mov_b32 v137, 0
    v_mov_b32 v138, 0
    v_mov_b32 v139, 0
    v_mov_b32 v140, 0
    v_mov_b32 v141, 0
    v_mov_b32 v142, 0
    v_mov_b32 v143, 0
    v_mov_b32 v96, 0
    v_mov_b32 v97, 0
    v_mov_b32 v98, 0
    v_mov_b32 v99, 0
    v_mov_b32 v100, 0
    v_mov_b32 v101, 0
    v_mov_b32 v102, 0
    v_mov_b32 v103, 0
    v_mov_b32 v172, 0
    v_mov_b32 v173, 0
    v_mov_b32 v174, 0
    v_mov_b32 v175, 0
    v_mov_b32 v176, 0
    v_mov_b32 v177, 0
    v_mov_b32 v178, 0
    v_mov_b32 v179, 0
    s_cmp_lg_u32 s42, 0
    s_cbranch_scc1 sequential_preLN__softmax_full_mha__glu_gated_glu__prompt_kernel_b3b
    s_lshr_b32 s45, s40, 1
    s_add_u32 s45, s45, 16
    s_lshl_b32 s45, s45, 8
    v_mov_b32 v30, s45
    s_mov_b64 exec, 1
    s_mov_b32 s45, 0x20000
sequential_preLN__softmax_full_mha__glu_gated_glu__prompt_kernel_poll4:
    buffer_load_dword v31, v30, s[84:87], 0 offen sc1
    s_sub_u32 s45, s45, 1
    s_cbranch_scc1 sequential_preLN__softmax_full_mha__glu_gated_glu__prompt_kernel_poll4x
    s_waitcnt vmcnt(0)
    v_cmp_gt_u32 vcc, 16, v31
    s_and_b64 vcc, vcc, exec
    s_cbranch_scc1 sequential_preLN__softmax_full_mha__glu_gated_glu__prompt_kernel_poll4
sequential_preLN__softmax_full_mha__glu_gated_glu__prompt_kernel_poll4x:
    s_mov_b64 exec, -1
sequential_preLN__softmax_full_mha__glu_gated_glu__prompt_kernel_b3b:
    s_barrier
    s_mov_b32 m0, s18
    s_add_u32 s18, s18, 16384
    buffer_load_dwordx4 v4, s[4:7], s16 offen offset:0 sc1 lds
    buffer_load_dwordx4 v4, s[4:7], s16 offen offset:1024 sc1 lds
    buffer_load_dwordx4 v4, s[4:7], s16 offen offset:2048 sc1 lds
    buffer_load_dwordx4 v4, s[4:7], s16 offen offset:3072 sc1 lds
    s_add_u32 s16, s16, 16384
    s_and_b32 s18, s18, 0xffff
    buffer_load_dwordx4 v[8:11], v4, s[8:11], s17 offen offset:0 sc1
    buffer_load_dwordx4 v[12:15], v4, s[8:11], s17 offen offset:1024 sc1
    buffer_load_dwordx4 v[16:19], v4, s[8:11], s17 offen offset:2048 sc1
    buffer_load_dwordx4 v[20:23], v4, s[8:11], s17 offen offset:3072 sc1
    s_mov_b32 m0, s18
    s_add_u32 s18, s18, 16384
    buffer_load_dwordx4 v4, s[4:7], s16 offen offset:0 sc1 lds
    buffer_load_dwordx4 v4, s[4:7], s16 offen offset:1024 sc1 lds
    buffer_load_dwordx4 v4, s[4:7], s16 offen offset:2048 sc1 lds
    buffer_load_dwordx4 v4, s[4:7], s16 offen offset:3072 sc1 lds
    s_add_u32 s16, s16, 16384
    s_and_b32 s18, s18, 0xffff
    s_mov_b32 m0, s18
    s_add_u32 s18, s18, 16384
    buffer_load_dwordx4 v4, s[4:7], s16 offen offset:0 sc1 lds
    buffer_load_dwordx4 v4, s[4:7], s16 offen offset:1024 sc1 lds
    buffer_load_dwordx4 v4, s[4:7], s16 offen offset:2048 sc1 lds
    buffer_load_dwordx4 v4, s[4:7], s16 offen offset:3072 sc1 lds
    s_add_u32 s16, s16, 16384
    s_and_b32 s18, s18, 0xffff
    s_waitcnt vmcnt(8)
    s_barrier
    ds_read_b128 v[148:151], v5
    ds_read_b128 v[152:155], v5 offset:1024
    ds_read_b128 v[156:159], v5 offset:4096
    ds_read_b128 v[160:163], v5 offset:5120
    ds_read_b128 v[164:167], v5 offset:2048
    ds_read_b128 v[168:171], v5 offset:3072
    s_waitcnt lgkmcnt(4)
    v_mfma_f32_32x32x16_bf16 v[56:71], v[148:151], v[8:11], 0
    v_mfma_f32_32x32x16_bf16 v[56:71], v[152:155], v[12:15], v[56:71]
    v_mfma_f32_32x32x16_bf16 v[72:87], v[148:151], v[16:19], 0
    v_mfma_f32_32x32x16_bf16 v[72:87], v[152:155], v[20:23], v[72:87]
    s_nop 11
    v_max3_f32 v2, v56, v57, v58
    v_max3_f32 v2, v2, v59, v60
    v_max3_f32 v2, v2, v61, v62
    v_max3_f32 v2, v2, v63, v64
    v_max3_f32 v2, v2, v65, v66
    v_max3_f32 v2, v2, v67, v68
    v_max3_f32 v2, v2, v69, v70
    v_max_f32 v2, v2, v71
    v_mov_b32 v3, v2
    s_nop 1
    v_permlane32_swap_b32 v2, v3
    s_nop 1
    v_max_f32 v2, v2, v3
    v_sub_f32 v24, 0, v2
    v_sub_f32 v25, 0, v2
    v_sub_f32 v26, 0, v2
    v_sub_f32 v27, 0, v2
    v_sub_f32 v28, 0, v2
    v_sub_f32 v29, 0, v2
    v_sub_f32 v30, 0, v2
    v_sub_f32 v31, 0, v2
    v_sub_f32 v32, 0, v2
    v_sub_f32 v33, 0, v2
    v_sub_f32 v34, 0, v2
    v_sub_f32 v35, 0, v2
    v_sub_f32 v36, 0, v2
    v_sub_f32 v37, 0, v2
    v_sub_f32 v38, 0, v2
    v_sub_f32 v39, 0, v2
    v_sub_f32 v56, v56, v2
    v_sub_f32 v57, v57, v2
    v_sub_f32 v58, v58, v2
    v_sub_f32 v59, v59, v2
    v_sub_f32 v60, v60, v2
    v_sub_f32 v61, v61, v2
    v_sub_f32 v62, v62, v2
    v_sub_f32 v63, v63, v2
    v_sub_f32 v64, v64, v2
    v_sub_f32 v65, v65, v2
    v_sub_f32 v66, v66, v2
    v_sub_f32 v67, v67, v2
    v_sub_f32 v68, v68, v2
    v_sub_f32 v69, v69, v2
    v_sub_f32 v70, v70, v2
    v_sub_f32 v71, v71, v2
    v_max3_f32 v2, v72, v73, v74
    v_max3_f32 v2, v2, v75, v76
    v_max3_f32 v2, v2, v77, v78
    v_max3_f32 v2, v2, v79, v80
    v_max3_f32 v2, v2, v81, v82
    v_max3_f32 v2, v2, v83, v84
    v_max3_f32 v2, v2, v85, v86
    v_max_f32 v2, v2, v87
    v_mov_b32 v3, v2
    s_nop 1
    v_permlane32_swap_b32 v2, v3
    s_nop 1
    v_max_f32 v2, v2, v3
    v_sub_f32 v40, 0, v2
    v_sub_f32 v41, 0, v2
    v_sub_f32 v42, 0, v2
    v_sub_f32 v43, 0, v2
    v_sub_f32 v44, 0, v2
    v_sub_f32 v45, 0, v2
    v_sub_f32 v46, 0, v2
    v_sub_f32 v47, 0, v2
    v_sub_f32 v48, 0, v2
    v_sub_f32 v49, 0, v2
    v_sub_f32 v50, 0, v2
    v_sub_f32 v51, 0, v2
    v_sub_f32 v52, 0, v2
    v_sub_f32 v53, 0, v2
    v_sub_f32 v54, 0, v2
    v_sub_f32 v55, 0, v2
    v_mov_b32 v86, 0
    v_mov_b32 v87, 0
    s_mov_b32 s20, 16
sequential_preLN__softmax_full_mha__glu_gated_glu__prompt_kernel_p2loop:
    v_mfma_f32_32x32x16_bf16 v[120:135], v[172:175], v[96:99], v[120:135]
    s_add_u32 m0, s19, s22
    v_cvt_pk_bf16_f32 v103, v86, v87
    v_exp_f32 v56, v56
    v_exp_f32 v57, v57
    v_exp_f32 v58, v58
    v_mfma_f32_32x32x16_bf16 v[72:87], v[148:151], v[16:19], v[40:55]
    s_add_u32 s21, s21, 57344
    v_exp_f32 v59, v59
    v_cvt_pk_bf16_f32 v88, v56, v57
    v_exp_f32 v60, v60
    v_exp_f32 v61, v61
    v_mfma_f32_16x16x32_bf16 v[140:143], v[144:147], v[96:99], v[140:143]
    buffer_load_dwordx4 v7, s[52:55], s21 offen lds
    v_cvt_pk_bf16_f32 v89, v58, v59
    v_exp_f32 v62, v62
    v_mfma_f32_32x32x16_bf16 v[72:87], v[152:155], v[20:23], v[72:87]
    s_add_u32 m0, s19, 16384
    v_exp_f32 v63, v63
    v_cvt_pk_bf16_f32 v90, v60, v61
    v_exp_f32 v64, v64
    v_exp_f32 v65, v65
    v_mfma_f32_32x32x16_bf16 v[120:135], v[176:179], v[100:103], v[120:135]
    s_sub_u32 s20, s20, 1
    v_cvt_pk_bf16_f32 v91, v62, v63
    v_exp_f32 v66, v66
    v_exp_f32 v67, v67
    v_cvt_pk_bf16_f32 v92, v64, v65
    v_mfma_f32_16x16x32_bf16 v[140:143], v[144:147], v[100:103], v[140:143]
    s_waitcnt lgkmcnt(0)
    v_exp_f32 v68, v68
    v_exp_f32 v69, v69
    v_cvt_pk_bf16_f32 v93, v66, v67
    v_exp_f32 v70, v70
    v_exp_f32 v71, v71
    v_cvt_pk_bf16_f32 v94, v68, v69
    v_mfma_f32_32x32x16_bf16 v[104:119], v[164:167], v[88:91], v[104:119]
    ds_read_b128 v[148:151], v5 offset:8192
    v_cvt_pk_bf16_f32 v95, v70, v71
    v_exp_f32 v72, v72
    v_exp_f32 v73, v73
    v_exp_f32 v74, v74
    v_mfma_f32_32x32x16_bf16 v[56:71], v[156:159], v[8:11], v[24:39]
    ds_read_b128 v[152:155], v5 offset:9216
    v_exp_f32 v75, v75
    v_cvt_pk_bf16_f32 v96, v72, v73
    v_exp_f32 v76, v76
    v_exp_f32 v77, v77
    v_mfma_f32_16x16x32_bf16 v[136:139], v[144:147], v[88:91], v[136:139]
    ds_read_b128 v[172:175], v6 offset:6144
    v_cvt_pk_bf16_f32 v97, v74, v75
    v_exp_f32 v78, v78
    v_mfma_f32_32x32x16_bf16 v[56:71], v[160:163], v[12:15], v[56:71]
    ds_read_b128 v[176:179], v6 offset:7168
    v_exp_f32 v79, v79
    v_cvt_pk_bf16_f32 v98, v76, v77
    v_exp_f32 v80, v80
    v_exp_f32 v81, v81
    v_mfma_f32_32x32x16_bf16 v[104:119], v[168:171], v[92:95], v[104:119]
    buffer_load_dwordx4 v4, s[56:59], s22 offen lds
    v_cvt_pk_bf16_f32 v99, v78, v79
    v_exp_f32 v82, v82
    v_exp_f32 v83, v83
    v_cvt_pk_bf16_f32 v100, v80, v81
    v_mfma_f32_16x16x32_bf16 v[136:139], v[144:147], v[92:95], v[136:139]
    s_add_u32 s22, s22, 1024
    v_exp_f32 v84, v84
    v_exp_f32 v85, v85
    v_cvt_pk_bf16_f32 v101, v82, v83
    v_exp_f32 v86, v86
    v_exp_f32 v87, v87
    v_cvt_pk_bf16_f32 v102, v84, v85
    v_mfma_f32_32x32x16_bf16 v[120:135], v[164:167], v[96:99], v[120:135]
    v_cvt_pk_bf16_f32 v103, v86, v87
    v_exp_f32 v56, v56
    v_exp_f32 v57, v57
    v_exp_f32 v58, v58
    v_mfma_f32_32x32x16_bf16 v[72:87], v[156:159], v[16:19], v[40:55]
    v_exp_f32 v59, v59
    v_cvt_pk_bf16_f32 v88, v56, v57
    v_exp_f32 v60, v60
    v_exp_f32 v61, v61
    v_mfma_f32_16x16x32_bf16 v[140:143], v[144:147], v[96:99], v[140:143]
    v_cvt_pk_bf16_f32 v89, v58, v59
    v_exp_f32 v62, v62
    v_mfma_f32_32x32x16_bf16 v[72:87], v[160:163], v[20:23], v[72:87]
    v_exp_f32 v63, v63
    v_cvt_pk_bf16_f32 v90, v60, v61
    v_exp_f32 v64, v64
    v_exp_f32 v65, v65
    v_mfma_f32_32x32x16_bf16 v[120:135], v[168:171], v[100:103], v[120:135]
    v_cvt_pk_bf16_f32 v91, v62, v63
    v_exp_f32 v66, v66
    v_exp_f32 v67, v67
    v_cvt_pk_bf16_f32 v92, v64, v65
    v_mfma_f32_16x16x32_bf16 v[140:143], v[144:147], v[100:103], v[140:143]
    s_waitcnt lgkmcnt(0)
    v_exp_f32 v68, v68
    v_exp_f32 v69, v69
    v_cvt_pk_bf16_f32 v93, v66, v67
    v_exp_f32 v70, v70
    v_exp_f32 v71, v71
    v_cvt_pk_bf16_f32 v94, v68, v69
    v_mfma_f32_32x32x16_bf16 v[104:119], v[172:175], v[88:91], v[104:119]
    ds_read_b128 v[156:159], v5 offset:12288
    v_cvt_pk_bf16_f32 v95, v70, v71
    v_exp_f32 v72, v72
    v_exp_f32 v73, v73
    v_exp_f32 v74, v74
    v_mfma_f32_32x32x16_bf16 v[56:71], v[148:151], v[8:11], v[24:39]
    ds_read_b128 v[160:163], v5 offset:13312
    v_exp_f32 v75, v75
    v_cvt_pk_bf16_f32 v96, v72, v73
    v_exp_f32 v76, v76
    v_exp_f32 v77, v77
    v_mfma_f32_16x16x32_bf16 v[136:139], v[144:147], v[88:91], v[136:139]
    ds_read_b128 v[164:167], v6 offset:10240
    v_cvt_pk_bf16_f32 v97, v74, v75
    v_exp_f32 v78, v78
    v_mfma_f32_32x32x16_bf16 v[56:71], v[152:155], v[12:15], v[56:71]
    ds_read_b128 v[168:171], v6 offset:11264
    v_exp_f32 v79, v79
    v_cvt_pk_bf16_f32 v98, v76, v77
    v_exp_f32 v80, v80
    v_exp_f32 v81, v81
    v_mfma_f32_32x32x16_bf16 v[104:119], v[176:179], v[92:95], v[104:119]
    v_cvt_pk_bf16_f32 v99, v78, v79
    v_exp_f32 v82, v82
    v_exp_f32 v83, v83
    v_cvt_pk_bf16_f32 v100, v80, v81
    v_mfma_f32_16x16x32_bf16 v[136:139], v[144:147], v[92:95], v[136:139]
    v_exp_f32 v84, v84
    v_exp_f32 v85, v85
    v_cvt_pk_bf16_f32 v101, v82, v83
    v_exp_f32 v86, v86
    v_exp_f32 v87, v87
    v_cvt_pk_bf16_f32 v102, v84, v85
    v_mfma_f32_32x32x16_bf16 v[120:135], v[172:175], v[96:99], v[120:135]
    v_cvt_pk_bf16_f32 v103, v86, v87
    v_exp_f32 v56, v56
    v_exp_f32 v57, v57
    v_exp_f32 v58, v58
    v_mfma_f32_32x32x16_bf16 v[72:87], v[148:151], v[16:19], v[40:55]
    v_exp_f32 v59, v59
    v_cvt_pk_bf16_f32 v88, v56, v57
    v_exp_f32 v60, v60
    v_exp_f32 v61, v61
    v_mfma_f32_16x16x32_bf16 v[140:143], v[144:147], v[96:99], v[140:143]
    v_cvt_pk_bf16_f32 v89, v58, v59
    v_exp_f32 v62, v62
    v_mfma_f32_32x32x16_bf16 v[72:87], v[152:155], v[20:23], v[72:87]
    s_waitcnt vmcnt(6)
    v_exp_f32 v63, v63
    v_cvt_pk_bf16_f32 v90, v60, v61
    v_exp_f32 v64, v64
    v_exp_f32 v65, v65
    v_mfma_f32_32x32x16_bf16 v[120:135], v[176:179], v[100:103], v[120:135]
    s_barrier
    v_cvt_pk_bf16_f32 v91, v62, v63
    v_exp_f32 v66, v66
    v_exp_f32 v67, v67
    v_cvt_pk_bf16_f32 v92, v64, v65
    v_mfma_f32_16x16x32_bf16 v[140:143], v[144:147], v[100:103], v[140:143]
    s_waitcnt lgkmcnt(0)
    v_exp_f32 v68, v68
    v_exp_f32 v69, v69
    v_cvt_pk_bf16_f32 v93, v66, v67
    v_exp_f32 v70, v70
    v_exp_f32 v71, v71
    v_cvt_pk_bf16_f32 v94, v68, v69
    v_add_u32 v5, 16384, v5
    v_and_b32 v5, 0xffff, v5
    v_mfma_f32_32x32x16_bf16 v[104:119], v[164:167], v[88:91], v[104:119]
    ds_read_b128 v[148:151], v5 offset:0
    v_cvt_pk_bf16_f32 v95, v70, v71
    v_exp_f32 v72, v72
    v_exp_f32 v73, v73
    v_exp_f32 v74, v74
    v_mfma_f32_32x32x16_bf16 v[56:71], v[156:159], v[8:11], v[24:39]
    ds_read_b128 v[152:155], v5 offset:1024
    v_exp_f32 v75, v75
    v_cvt_pk_bf16_f32 v96, v72, v73
    v_exp_f32 v76, v76
    v_exp_f32 v77, v77
    v_mfma_f32_16x16x32_bf16 v[136:139], v[144:147], v[88:91], v[136:139]
    ds_read_b128 v[172:175], v6 offset:14336
    v_cvt_pk_bf16_f32 v97, v74, v75
    v_exp_f32 v78, v78
    v_mfma_f32_32x32x16_bf16 v[56:71], v[160:163], v[12:15], v[56:71]
    ds_read_b128 v[176:179], v6 offset:15360
    v_exp_f32 v79, v79
    v_cvt_pk_bf16_f32 v98, v76, v77
    v_exp_f32 v80, v80
    v_exp_f32 v81, v81
    v_mfma_f32_32x32x16_bf16 v[104:119], v[168:171], v[92:95], v[104:119]
    s_mov_b32 m0, s18
    v_cvt_pk_bf16_f32 v99, v78, v79
    v_exp_f32 v82, v82
    v_exp_f32 v83, v83
    v_cvt_pk_bf16_f32 v100, v80, v81
    v_mfma_f32_16x16x32_bf16 v[136:139], v[144:147], v[92:95], v[136:139]
    s_add_u32 s18, s18, 16384
    v_exp_f32 v84, v84
    v_exp_f32 v85, v85
    v_cvt_pk_bf16_f32 v101, v82, v83
    v_exp_f32 v86, v86
    v_exp_f32 v87, v87
    v_cvt_pk_bf16_f32 v102, v84, v85
    v_mfma_f32_32x32x16_bf16 v[120:135], v[164:167], v[96:99], v[120:135]
    buffer_load_dwordx4 v4, s[4:7], s16 offen offset:0 sc1 lds
    v_cvt_pk_bf16_f32 v103, v86, v87
    v_exp_f32 v56, v56
    v_exp_f32 v57, v57
    v_exp_f32 v58, v58
    v_mfma_f32_32x32x16_bf16 v[72:87], v[156:159], v[16:19], v[40:55]
    buffer_load_dwordx4 v4, s[4:7], s16 offen offset:1024 sc1 lds
    v_exp_f32 v59, v59
    v_cvt_pk_bf16_f32 v88, v56, v57
    v_exp_f32 v60, v60
    v_exp_f32 v61, v61
    v_mfma_f32_16x16x32_bf16 v[140:143], v[144:147], v[96:99], v[140:143]
    buffer_load_dwordx4 v4, s[4:7], s16 offen offset:2048 sc1 lds
    v_cvt_pk_bf16_f32 v89, v58, v59
    v_exp_f32 v62, v62
    v_mfma_f32_32x32x16_bf16 v[72:87], v[160:163], v[20:23], v[72:87]
    buffer_load_dwordx4 v4, s[4:7], s16 offen offset:3072 sc1 lds
    v_exp_f32 v63, v63
    v_cvt_pk_bf16_f32 v90, v60, v61
    v_exp_f32 v64, v64
    v_exp_f32 v65, v65
    v_mfma_f32_32x32x16_bf16 v[120:135], v[168:171], v[100:103], v[120:135]
    s_add_u32 s16, s16, 16384
    v_cvt_pk_bf16_f32 v91, v62, v63
    v_exp_f32 v66, v66
    v_exp_f32 v67, v67
    v_cvt_pk_bf16_f32 v92, v64, v65
    v_mfma_f32_16x16x32_bf16 v[140:143], v[144:147], v[100:103], v[140:143]
    s_waitcnt lgkmcnt(0)
    v_exp_f32 v68, v68
    v_exp_f32 v69, v69
    v_cvt_pk_bf16_f32 v93, v66, v67
    v_exp_f32 v70, v70
    v_exp_f32 v71, v71
    v_cvt_pk_bf16_f32 v94, v68, v69
    v_mov_b32 v6, v5
    v_mfma_f32_32x32x16_bf16 v[104:119], v[172:175], v[88:91], v[104:119]
    ds_read_b128 v[156:159], v5 offset:4096
    v_cvt_pk_bf16_f32 v95, v70, v71
    v_exp_f32 v72, v72
    v_exp_f32 v73, v73
    v_exp_f32 v74, v74
    v_mfma_f32_32x32x16_bf16 v[56:71], v[148:151], v[8:11], v[24:39]
    ds_read_b128 v[160:163], v5 offset:5120
    v_exp_f32 v75, v75
    v_cvt_pk_bf16_f32 v96, v72, v73
    v_exp_f32 v76, v76
    v_exp_f32 v77, v77
    v_mfma_f32_16x16x32_bf16 v[136:139], v[144:147], v[88:91], v[136:139]
    ds_read_b128 v[164:167], v5 offset:2048
    v_cvt_pk_bf16_f32 v97, v74, v75
    v_exp_f32 v78, v78
    v_mfma_f32_32x32x16_bf16 v[56:71], v[152:155], v[12:15], v[56:71]
    ds_read_b128 v[168:171], v5 offset:3072
    v_exp_f32 v79, v79
    v_cvt_pk_bf16_f32 v98, v76, v77
    v_exp_f32 v80, v80
    v_exp_f32 v81, v81
    v_mfma_f32_32x32x16_bf16 v[104:119], v[176:179], v[92:95], v[104:119]
    s_and_b32 s18, s18, 0xffff
    v_cvt_pk_bf16_f32 v99, v78, v79
    v_exp_f32 v82, v82
    v_exp_f32 v83, v83
    v_cvt_pk_bf16_f32 v100, v80, v81
    v_mfma_f32_16x16x32_bf16 v[136:139], v[144:147], v[92:95], v[136:139]
    s_cmp_lg_u32 s20, 0
    v_exp_f32 v84, v84
    v_exp_f32 v85, v85
    v_cvt_pk_bf16_f32 v101, v82, v83
    v_exp_f32 v86, v86
    v_exp_f32 v87, v87
    v_cvt_pk_bf16_f32 v102, v84, v85
    s_cbranch_scc1 sequential_preLN__softmax_full_mha__glu_gated_glu__prompt_kernel_p2loop
    v_cvt_pk_bf16_f32 v103, v86, v87
    v_mfma_f32_32x32x16_bf16 v[120:135], v[172:175], v[96:99], v[120:135]
    v_mfma_f32_16x16x32_bf16 v[140:143], v[144:147], v[96:99], v[140:143]
    v_mfma_f32_32x32x16_bf16 v[120:135], v[176:179], v[100:103], v[120:135]
    v_mfma_f32_16x16x32_bf16 v[140:143], v[144:147], v[100:103], v[140:143]
    v_lshrrev_b32 v2, 2, v1
    v_and_b32 v3, 3, v1
    v_lshlrev_b32 v2, 7, v2
    v_lshl_add_u32 v2, v3, 3, v2
    v_add_u32 v2, s19, v2
    s_waitcnt vmcnt(0) lgkmcnt(0)
    v_mov_b32 v148, 0x3f803f80
    v_mov_b32 v149, 0x3f803f80
    v_mov_b32 v150, 0x3f803f80
    v_mov_b32 v151, 0x3f803f80
    ds_read_b64_tr_b16 v[24:25], v2 offset:0
    ds_read_b64_tr_b16 v[26:27], v2 offset:2048
    ds_read_b64_tr_b16 v[28:29], v2 offset:32
    ds_read_b64_tr_b16 v[30:31], v2 offset:2080
    ds_read_b64_tr_b16 v[32:33], v2 offset:64
    ds_read_b64_tr_b16 v[34:35], v2 offset:2112
    ds_read_b64_tr_b16 v[36:37], v2 offset:96
    ds_read_b64_tr_b16 v[38:39], v2 offset:2144
    ds_read_b64_tr_b16 v[40:41], v2 offset:4096
    ds_read_b64_tr_b16 v[42:43], v2 offset:6144
    ds_read_b64_tr_b16 v[44:45], v2 offset:4128
    ds_read_b64_tr_b16 v[46:47], v2 offset:6176
    ds_read_b64_tr_b16 v[48:49], v2 offset:4160
    ds_read_b64_tr_b16 v[50:51], v2 offset:6208
    ds_read_b64_tr_b16 v[52:53], v2 offset:4192
    ds_read_b64_tr_b16 v[54:55], v2 offset:6240
    s_waitcnt lgkmcnt(0)
    v_mfma_f32_16x16x32_bf16 v[164:167], v[148:151], v[24:27], 0
    v_mfma_f32_16x16x32_bf16 v[168:171], v[148:151], v[28:31], 0
    v_mfma_f32_16x16x32_bf16 v[172:175], v[148:151], v[32:35], 0
    v_mfma_f32_16x16x32_bf16 v[176:179], v[148:151], v[36:39], 0
    v_mfma_f32_16x16x32_bf16 v[164:167], v[148:151], v[40:43], v[164:167]
    v_mfma_f32_16x16x32_bf16 v[168:171], v[148:151], v[44:47], v[168:171]
    v_mfma_f32_16x16x32_bf16 v[172:175], v[148:151], v[48:51], v[172:175]
    v_mfma_f32_16x16x32_bf16 v[176:179], v[148:151], v[52:55], v[176:179]
    ds_read_b64_tr_b16 v[56:57], v2 offset:8192
    ds_read_b64_tr_b16 v[58:59], v2 offset:10240
    ds_read_b64_tr_b16 v[60:61], v2 offset:8224
    ds_read_b64_tr_b16 v[62:63], v2 offset:10272
    ds_read_b64_tr_b16 v[64:65], v2 offset:8256
    ds_read_b64_tr_b16 v[66:67], v2 offset:10304
    ds_read_b64_tr_b16 v[68:69], v2 offset:8288
    ds_read_b64_tr_b16 v[70:71], v2 offset:10336
    ds_read_b64_tr_b16 v[72:73], v2 offset:12288
    ds_read_b64_tr_b16 v[74:75], v2 offset:14336
    ds_read_b64_tr_b16 v[76:77], v2 offset:12320
    ds_read_b64_tr_b16 v[78:79], v2 offset:14368
    ds_read_b64_tr_b16 v[80:81], v2 offset:12352
    ds_read_b64_tr_b16 v[82:83], v2 offset:14400
    ds_read_b64_tr_b16 v[84:85], v2 offset:12384
    ds_read_b64_tr_b16 v[86:87], v2 offset:14432
    s_waitcnt lgkmcnt(0)
    v_mfma_f32_16x16x32_bf16 v[164:167], v[148:151], v[56:59], v[164:167]
    v_mfma_f32_16x16x32_bf16 v[168:171], v[148:151], v[60:63], v[168:171]
    v_mfma_f32_16x16x32_bf16 v[172:175], v[148:151], v[64:67], v[172:175]
    v_mfma_f32_16x16x32_bf16 v[176:179], v[148:151], v[68:71], v[176:179]
    v_mfma_f32_16x16x32_bf16 v[164:167], v[148:151], v[72:75], v[164:167]
    v_mfma_f32_16x16x32_bf16 v[168:171], v[148:151], v[76:79], v[168:171]
    v_mfma_f32_16x16x32_bf16 v[172:175], v[148:151], v[80:83], v[172:175]
    v_mfma_f32_16x16x32_bf16 v[176:179], v[148:151], v[84:87], v[176:179]
    s_barrier
    s_add_u32 s56, s82, 42991616
    s_addc_u32 s57, s83, 0
    s_and_b32 s57, s57, 0xffff
    s_mov_b32 s58, 229376
    s_mov_b32 s59, 0x20000
    s_cmp_ge_u32 s48, 112
    s_cselect_b32 s58, 0, s58
    s_mul_i32 s45, s49, 28672
    s_lshl_b32 s46, s48, 8
    s_add_u32 s45, s45, s46
    v_lshlrev_b32 v2, 2, v1
    s_mov_b64 exec, 0xffff
    buffer_store_dword v164, v2, s[56:59], s45 offen offset:0 sc1
    buffer_store_dword v168, v2, s[56:59], s45 offen offset:64 sc1
    buffer_store_dword v172, v2, s[56:59], s45 offen offset:128 sc1
    buffer_store_dword v176, v2, s[56:59], s45 offen offset:192 sc1
    s_mov_b64 exec, -1
    v_mul_f32 v2, 0, v136
    v_fmac_f32 v2, 0, v140
    v_fmac_f32 v2, 0, v104
    v_fmac_f32 v2, 0, v105
    v_fmac_f32 v2, 0, v106
    v_fmac_f32 v2, 0, v107
    v_fmac_f32 v2, 0, v108
    v_fmac_f32 v2, 0, v109
    v_fmac_f32 v2, 0, v110
    v_fmac_f32 v2, 0, v111
    v_fmac_f32 v2, 0, v112
    v_fmac_f32 v2, 0, v113
    v_fmac_f32 v2, 0, v114
    v_fmac_f32 v2, 0, v115
    v_fmac_f32 v2, 0, v116
    v_fmac_f32 v2, 0, v117
    v_fmac_f32 v2, 0, v118
    v_fmac_f32 v2, 0, v119
    v_fmac_f32 v2, 0, v120
    v_fmac_f32 v2, 0, v121
    v_fmac_f32 v2, 0, v122
    v_fmac_f32 v2, 0, v123
    v_fmac_f32 v2, 0, v124
    v_fmac_f32 v2, 0, v125
    v_fmac_f32 v2, 0, v126
    v_fmac_f32 v2, 0, v127
    v_fmac_f32 v2, 0, v128
    v_fmac_f32 v2, 0, v129
    v_fmac_f32 v2, 0, v130
    v_fmac_f32 v2, 0, v131
    v_fmac_f32 v2, 0, v132
    v_fmac_f32 v2, 0, v133
    v_fmac_f32 v2, 0, v134
    v_fmac_f32 v2, 0, v135
    v_cmp_u_f32 vcc, v2, v2
    s_nop 4
    s_cbranch_vccz sequential_preLN__softmax_full_mha__glu_gated_glu__prompt_kernel_fin
    s_mov_b32 s16, 0
    s_mov_b32 s20, 64
    v_mov_b32 v6, 0xff800000
    v_mov_b32 v7, 0xff800000
    v_mov_b32 v104, 0
    v_mov_b32 v105, 0
    v_mov_b32 v106, 0
    v_mov_b32 v107, 0
    v_mov_b32 v108, 0
    v_mov_b32 v109, 0
    v_mov_b32 v110, 0
    v_mov_b32 v111, 0
    v_mov_b32 v112, 0
    v_mov_b32 v113, 0
    v_mov_b32 v114, 0
    v_mov_b32 v115, 0
    v_mov_b32 v116, 0
    v_mov_b32 v117, 0
    v_mov_b32 v118, 0
    v_mov_b32 v119, 0
    v_mov_b32 v120, 0
    v_mov_b32 v121, 0
    v_mov_b32 v122, 0
    v_mov_b32 v123, 0
    v_mov_b32 v124, 0
    v_mov_b32 v125, 0
    v_mov_b32 v126, 0
    v_mov_b32 v127, 0
    v_mov_b32 v128, 0
    v_mov_b32 v129, 0
    v_mov_b32 v130, 0
    v_mov_b32 v131, 0
    v_mov_b32 v132, 0
    v_mov_b32 v133, 0
    v_mov_b32 v134, 0
    v_mov_b32 v135, 0
    v_mov_b32 v136, 0
    v_mov_b32 v137, 0
    v_mov_b32 v138, 0
    v_mov_b32 v139, 0
    v_mov_b32 v140, 0
    v_mov_b32 v141, 0
    v_mov_b32 v142, 0
    v_mov_b32 v143, 0
sequential_preLN__softmax_full_mha__glu_gated_glu__prompt_kernel_fb:
    buffer_load_dwordx4 v[148:151], v4, s[4:7], s16 offen sc1
    buffer_load_dwordx4 v[152:155], v4, s[4:7], s16 offen offset:1024 sc1
    buffer_load_dwordx4 v[164:167], v4, s[4:7], s16 offen offset:2048 sc1
    buffer_load_dwordx4 v[168:171], v4, s[4:7], s16 offen offset:3072 sc1
    s_add_u32 s16, s16, 4096
    s_waitcnt vmcnt(0)
    v_mfma_f32_32x32x16_bf16 v[56:71], v[148:151], v[8:11], 0
    v_mfma_f32_32x32x16_bf16 v[56:71], v[152:155], v[12:15], v[56:71]
    s_nop 15
    v_max3_f32 v2, v56, v57, v58
    v_max3_f32 v2, v2, v59, v60
    v_max3_f32 v2, v2, v61, v62
    v_max3_f32 v2, v2, v63, v64
    v_max3_f32 v2, v2, v65, v66
    v_max3_f32 v2, v2, v67, v68
    v_max3_f32 v2, v2, v69, v70
    v_max_f32 v2, v2, v71
    v_mov_b32 v3, v2
    s_nop 1
    v_permlane32_swap_b32 v2, v3
    s_nop 1
    v_max_f32 v2, v2, v3
    v_max_f32 v2, v2, v6
    v_sub_f32 v3, v6, v2
    v_exp_f32 v3, v3
    v_mov_b32 v6, v2
    v_sub_f32 v56, v56, v2
    v_sub_f32 v57, v57, v2
    v_sub_f32 v58, v58, v2
    v_sub_f32 v59, v59, v2
    v_sub_f32 v60, v60, v2
    v_sub_f32 v61, v61, v2
    v_sub_f32 v62, v62, v2
    v_sub_f32 v63, v63, v2
    v_sub_f32 v64, v64, v2
    v_sub_f32 v65, v65, v2
    v_sub_f32 v66, v66, v2
    v_sub_f32 v67, v67, v2
    v_sub_f32 v68, v68, v2
    v_sub_f32 v69, v69, v2
    v_sub_f32 v70, v70, v2
    v_sub_f32 v71, v71, v2
    v_exp_f32 v56, v56
    v_exp_f32 v57, v57
    v_exp_f32 v58, v58
    v_exp_f32 v59, v59
    v_exp_f32 v60, v60
    v_exp_f32 v61, v61
    v_exp_f32 v62, v62
    v_exp_f32 v63, v63
    v_exp_f32 v64, v64
    v_exp_f32 v65, v65
    v_exp_f32 v66, v66
    v_exp_f32 v67, v67
    v_exp_f32 v68, v68
    v_exp_f32 v69, v69
    v_exp_f32 v70, v70
    v_exp_f32 v71, v71
    v_mul_f32 v104, v104, v3
    v_mul_f32 v105, v105, v3
    v_mul_f32 v106, v106, v3
    v_mul_f32 v107, v107, v3
    v_mul_f32 v108, v108, v3
    v_mul_f32 v109, v109, v3
    v_mul_f32 v110, v110, v3
    v_mul_f32 v111, v111, v3
    v_mul_f32 v112, v112, v3
    v_mul_f32 v113, v113, v3
    v_mul_f32 v114, v114, v3
    v_mul_f32 v115, v115, v3
    v_mul_f32 v116, v116, v3
    v_mul_f32 v117, v117, v3
    v_mul_f32 v118, v118, v3
    v_mul_f32 v119, v119, v3
    v_mul_f32 v136, v136, v3
    v_mul_f32 v137, v137, v3
    v_mul_f32 v138, v138, v3
    v_mul_f32 v139, v139, v3
    v_cvt_pk_bf16_f32 v88, v56, v57
    v_cvt_pk_bf16_f32 v89, v58, v59
    v_cvt_pk_bf16_f32 v90, v60, v61
    v_cvt_pk_bf16_f32 v91, v62, v63
    v_cvt_pk_bf16_f32 v92, v64, v65
    v_cvt_pk_bf16_f32 v93, v66, v67
    v_cvt_pk_bf16_f32 v94, v68, v69
    v_cvt_pk_bf16_f32 v95, v70, v71
    s_nop 1
    v_mfma_f32_32x32x16_bf16 v[104:119], v[164:167], v[88:91], v[104:119]
    v_mfma_f32_16x16x32_bf16 v[136:139], v[144:147], v[88:91], v[136:139]
    v_mfma_f32_32x32x16_bf16 v[104:119], v[168:171], v[92:95], v[104:119]
    v_mfma_f32_16x16x32_bf16 v[136:139], v[144:147], v[92:95], v[136:139]
    v_mfma_f32_32x32x16_bf16 v[56:71], v[148:151], v[16:19], 0
    v_mfma_f32_32x32x16_bf16 v[56:71], v[152:155], v[20:23], v[56:71]
    s_nop 15
    v_max3_f32 v2, v56, v57, v58
    v_max3_f32 v2, v2, v59, v60
    v_max3_f32 v2, v2, v61, v62
    v_max3_f32 v2, v2, v63, v64
    v_max3_f32 v2, v2, v65, v66
    v_max3_f32 v2, v2, v67, v68
    v_max3_f32 v2, v2, v69, v70
    v_max_f32 v2, v2, v71
    v_mov_b32 v3, v2
    s_nop 1
    v_permlane32_swap_b32 v2, v3
    s_nop 1
    v_max_f32 v2, v2, v3
    v_max_f32 v2, v2, v7
    v_sub_f32 v3, v7, v2
    v_exp_f32 v3, v3
    v_mov_b32 v7, v2
    v_sub_f32 v56, v56, v2
    v_sub_f32 v57, v57, v2
    v_sub_f32 v58, v58, v2
    v_sub_f32 v59, v59, v2
    v_sub_f32 v60, v60, v2
    v_sub_f32 v61, v61, v2
    v_sub_f32 v62, v62, v2
    v_sub_f32 v63, v63, v2
    v_sub_f32 v64, v64, v2
    v_sub_f32 v65, v65, v2
    v_sub_f32 v66, v66, v2
    v_sub_f32 v67, v67, v2
    v_sub_f32 v68, v68, v2
    v_sub_f32 v69, v69, v2
    v_sub_f32 v70, v70, v2
    v_sub_f32 v71, v71, v2
    v_exp_f32 v56, v56
    v_exp_f32 v57, v57
    v_exp_f32 v58, v58
    v_exp_f32 v59, v59
    v_exp_f32 v60, v60
    v_exp_f32 v61, v61
    v_exp_f32 v62, v62
    v_exp_f32 v63, v63
    v_exp_f32 v64, v64
    v_exp_f32 v65, v65
    v_exp_f32 v66, v66
    v_exp_f32 v67, v67
    v_exp_f32 v68, v68
    v_exp_f32 v69, v69
    v_exp_f32 v70, v70
    v_exp_f32 v71, v71
    v_mul_f32 v120, v120, v3
    v_mul_f32 v121, v121, v3
    v_mul_f32 v122, v122, v3
    v_mul_f32 v123, v123, v3
    v_mul_f32 v124, v124, v3
    v_mul_f32 v125, v125, v3
    v_mul_f32 v126, v126, v3
    v_mul_f32 v127, v127, v3
    v_mul_f32 v128, v128, v3
    v_mul_f32 v129, v129, v3
    v_mul_f32 v130, v130, v3
    v_mul_f32 v131, v131, v3
    v_mul_f32 v132, v132, v3
    v_mul_f32 v133, v133, v3
    v_mul_f32 v134, v134, v3
    v_mul_f32 v135, v135, v3
    v_mul_f32 v140, v140, v3
    v_mul_f32 v141, v141, v3
    v_mul_f32 v142, v142, v3
    v_mul_f32 v143, v143, v3
    v_cvt_pk_bf16_f32 v88, v56, v57
    v_cvt_pk_bf16_f32 v89, v58, v59
    v_cvt_pk_bf16_f32 v90, v60, v61
    v_cvt_pk_bf16_f32 v91, v62, v63
    v_cvt_pk_bf16_f32 v92, v64, v65
    v_cvt_pk_bf16_f32 v93, v66, v67
    v_cvt_pk_bf16_f32 v94, v68, v69
    v_cvt_pk_bf16_f32 v95, v70, v71
    s_nop 1
    v_mfma_f32_32x32x16_bf16 v[120:135], v[164:167], v[88:91], v[120:135]
    v_mfma_f32_16x16x32_bf16 v[140:143], v[144:147], v[88:91], v[140:143]
    v_mfma_f32_32x32x16_bf16 v[120:135], v[168:171], v[92:95], v[120:135]
    v_mfma_f32_16x16x32_bf16 v[140:143], v[144:147], v[92:95], v[140:143]
    s_sub_u32 s20, s20, 1
    s_cmp_lg_u32 s20, 0
    s_nop 15
    s_cbranch_scc1 sequential_preLN__softmax_full_mha__glu_gated_glu__prompt_kernel_fb
sequential_preLN__softmax_full_mha__glu_gated_glu__prompt_kernel_fin:
    v_rcp_f32 v2, v136
    v_rcp_f32 v6, v140
    s_lshl_b32 s45, s41, 2
    s_add_u32 s45, s45, s42
    s_lshl_b32 s45, s45, 5
    s_add_u32 s45, s45, s40
    s_lshl_b32 s45, s45, 12
    v_and_b32 v3, 15, v1
    v_lshlrev_b32 v3, 4, v3
    v_and_b32 v5, 16, v1
    v_lshl_add_u32 v3, v5, 6, v3
    v_and_b32 v5, 32, v1
    v_lshl_add_u32 v3, v5, 3, v3
    v_mul_f32 v104, v104, v2
    v_mul_f32 v105, v105, v2
    v_mul_f32 v106, v106, v2
    v_mul_f32 v107, v107, v2
    v_mul_f32 v108, v108, v2
    v_mul_f32 v109, v109, v2
    v_mul_f32 v110, v110, v2
    v_mul_f32 v111, v111, v2
    v_mul_f32 v112, v112, v2
    v_mul_f32 v113, v113, v2
    v_mul_f32 v114, v114, v2
    v_mul_f32 v115, v115, v2
    v_mul_f32 v116, v116, v2
    v_mul_f32 v117, v117, v2
    v_mul_f32 v118, v118, v2
    v_mul_f32 v119, v119, v2
    v_cvt_pk_bf16_f32 v56, v104, v105
    v_cvt_pk_bf16_f32 v57, v106, v107
    v_cvt_pk_bf16_f32 v58, v112, v113
    v_cvt_pk_bf16_f32 v59, v114, v115
    buffer_store_dwordx4 v[56:59], v3, s[12:15], s45 offen offset:0 sc1
    v_cvt_pk_bf16_f32 v60, v108, v109
    v_cvt_pk_bf16_f32 v61, v110, v111
    v_cvt_pk_bf16_f32 v62, v116, v117
    v_cvt_pk_bf16_f32 v63, v118, v119
    buffer_store_dwordx4 v[60:63], v3, s[12:15], s45 offen offset:512 sc1
    v_mul_f32 v120, v120, v6
    v_mul_f32 v121, v121, v6
    v_mul_f32 v122, v122, v6
    v_mul_f32 v123, v123, v6
    v_mul_f32 v124, v124, v6
    v_mul_f32 v125, v125, v6
    v_mul_f32 v126, v126, v6
    v_mul_f32 v127, v127, v6
    v_mul_f32 v128, v128, v6
    v_mul_f32 v129, v129, v6
    v_mul_f32 v130, v130, v6
    v_mul_f32 v131, v131, v6
    v_mul_f32 v132, v132, v6
    v_mul_f32 v133, v133, v6
    v_mul_f32 v134, v134, v6
    v_mul_f32 v135, v135, v6
    v_cvt_pk_bf16_f32 v64, v120, v121
    v_cvt_pk_bf16_f32 v65, v122, v123
    v_cvt_pk_bf16_f32 v66, v128, v129
    v_cvt_pk_bf16_f32 v67, v130, v131
    buffer_store_dwordx4 v[64:67], v3, s[12:15], s45 offen offset:2048 sc1
    v_cvt_pk_bf16_f32 v68, v124, v125
    v_cvt_pk_bf16_f32 v69, v126, v127
    v_cvt_pk_bf16_f32 v70, v132, v133
    v_cvt_pk_bf16_f32 v71, v134, v135
    buffer_store_dwordx4 v[68:71], v3, s[12:15], s45 offen offset:2560 sc1
    s_add_u32 s92, s41, 32
    v_lshrrev_b32 v2, 4, v1
    v_and_b32 v3, 15, v1
    s_and_b32 s40, s38, 3
    s_lshl_b32 s40, s40, 3
    s_and_b32 s45, s39, 7
    s_add_u32 s40, s40, s45
    s_lshr_b32 s41, s38, 2
    s_lshl_b32 s41, s41, 2
    s_lshr_b32 s45, s39, 3
    s_add_u32 s41, s41, s45
    s_lshr_b32 s43, s42, 1
    s_and_b32 s44, s42, 1
    v_lshlrev_b32 v4, 4, v1
    s_lshr_b32 s45, s42, 2
    s_lshl_b32 s46, s40, 0
    s_add_u32 s45, s45, s46
    s_mul_i32 s31, s45, 131072
    s_and_b32 s46, s42, 3
    s_mul_i32 s16, s46, 2048
    s_mul_i32 s18, s42, 2048
    s_lshl_b32 s45, s43, 11
    v_add_u32 v24, s45, v4
    v_lshrrev_b32 v20, 3, v1
    v_and_b32 v21, 7, v1
    v_and_b32 v22, 6, v20
    v_xor_b32 v21, v21, v22
    v_lshlrev_b32 v21, 4, v21
    v_mul_u32_u24 v20, 2048, v20
    v_add_u32 v20, v20, v21
    s_mul_i32 s17, s42, 32768
    s_mul_i32 s45, s41, 256
    s_add_u32 s17, s17, s45
    s_mul_i32 s19, s42, 4096
    s_add_u32 s19, s19, 8192
    v_add_u32 v8, 4096, v20
    v_add_u32 v9, 3200, v20
    v_add_u32 v10, 18432, v20
    v_add_u32 v11, 17536, v20
    s_sub_u32 s17, s17, 131072
    s_sub_u32 s16, s16, 8192
    s_add_u32 s4, s82, 16777216
    s_addc_u32 s5, s83, 0
    s_and_b32 s5, s5, 0xffff
    s_mov_b32 s6, 4194304
    s_mov_b32 s7, 0x20000
    s_sub_u32 s8, s68, 4096
    s_subb_u32 s9, s69, 0
    s_and_b32 s9, s9, 0xffff
    s_mov_b32 s10, 2101248
    s_mov_b32 s11, 0x20000
    s_add_u32 s12, s82, 20971520
    s_addc_u32 s13, s83, 0
    s_and_b32 s13, s13, 0xffff
    s_mov_b32 s14, 4194304
    s_mov_b32 s15, 0x20000
    s_mov_b32 s52, s64
    s_and_b32 s53, s65, 0xffff
    s_mov_b32 s54, 4194304
    s_mov_b32 s55, 0x20000
    s_add_u32 s56, s82, 41943040
    s_addc_u32 s57, s83, 0
    s_and_b32 s57, s57, 0xffff
    s_mov_b32 s58, 262144
    s_mov_b32 s59, 0x20000
    s_add_u32 s4, s4, s31
    s_addc_u32 s5, s5, 0
    s_mov_b32 s6, 131072
    s_waitcnt vmcnt(0)
    s_barrier
    s_cmp_lg_u32 s42, 0
    s_cbranch_scc1 sequential_preLN__softmax_full_mha__glu_gated_glu__prompt_kernel_b5a
    s_lshl_b32 s92, s92, 8
    v_mov_b32 v30, s92
    v_mov_b32 v31, 1
    s_mov_b64 exec, 1
    buffer_atomic_add v31, v30, s[84:87], 0 offen sc1
    s_mov_b64 exec, -1
sequential_preLN__softmax_full_mha__glu_gated_glu__prompt_kernel_b5a:
    s_add_u32 m0, s19, 0
    s_add_u32 s17, s17, 131072
    buffer_load_dwordx4 v8, s[8:11], s17 offen offset:0 lds
    buffer_load_dwordx4 v9, s[8:11], s17 offen offset:1024 lds
    buffer_load_dwordx4 v10, s[8:11], s17 offen offset:2048 lds
    buffer_load_dwordx4 v11, s[8:11], s17 offen offset:3072 lds
    s_add_u32 m0, s19, 24576
    s_add_u32 s17, s17, 131072
    buffer_load_dwordx4 v8, s[8:11], s17 offen offset:0 lds
    buffer_load_dwordx4 v9, s[8:11], s17 offen offset:1024 lds
    buffer_load_dwordx4 v10, s[8:11], s17 offen offset:2048 lds
    buffer_load_dwordx4 v11, s[8:11], s17 offen offset:3072 lds
    s_add_u32 m0, s19, 49152
    s_add_u32 s17, s17, 131072
    buffer_load_dwordx4 v8, s[8:11], s17 offen offset:0 lds
    buffer_load_dwordx4 v9, s[8:11], s17 offen offset:1024 lds
    buffer_load_dwordx4 v10, s[8:11], s17 offen offset:2048 lds
    buffer_load_dwordx4 v11, s[8:11], s17 offen offset:3072 lds
    s_add_u32 m0, s19, 73728
    s_add_u32 s17, s17, 131072
    buffer_load_dwordx4 v8, s[8:11], s17 offen offset:0 lds
    buffer_load_dwordx4 v9, s[8:11], s17 offen offset:1024 lds
    buffer_load_dwordx4 v10, s[8:11], s17 offen offset:2048 lds
    buffer_load_dwordx4 v11, s[8:11], s17 offen offset:3072 lds
    v_lshrrev_b32 v20, 2, v1
    v_and_b32 v20, 7, v20
    v_lshrrev_b32 v21, 1, v20
    s_lshl_b32 s45, s44, 1
    v_xor_b32 v21, s45, v21
    v_lshlrev_b32 v21, 5, v21
    v_lshlrev_b32 v20, 7, v20
    v_lshrrev_b32 v22, 5, v1
    v_mul_u32_u24 v22, 2048, v22
    v_add_u32 v20, v20, v22
    v_and_b32 v22, 3, v1
    v_lshl_add_u32 v20, v22, 3, v20
    v_add_u32 v20, 8192, v20
    v_add_u32 v25, v20, v21
    v_xor_b32 v21, 32, v21
    v_add_u32 v26, v20, v21
    v_add_u32 v27, 49152, v24
    v_add_u32 v28, 49152, v25
    v_add_u32 v29, 49152, v26
    v_mov_b32 v32, 0
    v_mov_b32 v33, 0
    v_mov_b32 v34, 0
    v_mov_b32 v35, 0
    v_mov_b32 v36, 0
    v_mov_b32 v37, 0
    v_mov_b32 v38, 0
    v_mov_b32 v39, 0
    v_mov_b32 v40, 0
    v_mov_b32 v41, 0
    v_mov_b32 v42, 0
    v_mov_b32 v43, 0
    v_mov_b32 v44, 0
    v_mov_b32 v45, 0
    v_mov_b32 v46, 0
    v_mov_b32 v47, 0
    v_mov_b32 v48, 0
    v_mov_b32 v49, 0
    v_mov_b32 v50, 0
    v_mov_b32 v51, 0
    v_mov_b32 v52, 0
    v_mov_b32 v53, 0
    v_mov_b32 v54, 0
    v_mov_b32 v55, 0
    v_mov_b32 v56, 0
    v_mov_b32 v57, 0
    v_mov_b32 v58, 0
    v_mov_b32 v59, 0
    v_mov_b32 v60, 0
    v_mov_b32 v61, 0
    v_mov_b32 v62, 0
    v_mov_b32 v63, 0
    s_lshl_b32 s45, s40, 6
    s_lshl_b32 s46, s43, 5
    s_add_u32 s45, s45, s46
    v_add_u32 v17, s45, v3
    v_lshlrev_b32 v16, 11, v17
    s_lshl_b32 s45, s41, 8
    s_lshl_b32 s46, s44, 6
    s_add_u32 s45, s45, s46
    v_and_b32 v18, 1, v2
    v_lshl_add_u32 v16, v18, 5, v16
    v_lshrrev_b32 v18, 1, v2
    v_lshl_add_u32 v16, v18, 4, v16
    v_add_u32 v16, s45, v16
    s_lshl_b32 s45, s40, 5
    s_lshl_b32 s46, s41, 2
    s_add_u32 s45, s45, s46
    s_add_u32 s45, s45, s44
    s_lshl_b32 s45, s45, 12
    s_lshl_b32 s46, s43, 11
    s_add_u32 s50, s45, s46
    s_add_u32 s51, s50, 8192
    s_mov_b32 s49, 32768
    buffer_load_dwordx4 v[160:163], v16, s[52:55], 0 offen offset:0
    buffer_load_dwordx4 v[164:167], v16, s[52:55], s49 offen offset:0
    buffer_load_dwordx4 v[168:171], v16, s[52:55], 0 offen offset:128
    buffer_load_dwordx4 v[172:175], v16, s[52:55], s49 offen offset:128
    s_cmp_lg_u32 s42, 0
    s_cbranch_scc1 sequential_preLN__softmax_full_mha__glu_gated_glu__prompt_kernel_b5b
    s_lshr_b32 s45, s40, 2
    s_add_u32 s45, s45, 32
    s_lshl_b32 s45, s45, 8
    v_mov_b32 v30, s45
    s_mov_b64 exec, 1
    s_mov_b32 s45, 0x20000
sequential_preLN__softmax_full_mha__glu_gated_glu__prompt_kernel_poll6:
    buffer_load_dword v31, v30, s[84:87], 0 offen sc1
    s_sub_u32 s45, s45, 1
    s_cbranch_scc1 sequential_preLN__softmax_full_mha__glu_gated_glu__prompt_kernel_poll6x
    s_waitcnt vmcnt(0)
    v_cmp_gt_u32 vcc, 32, v31
    s_and_b64 vcc, vcc, exec
    s_cbranch_scc1 sequential_preLN__softmax_full_mha__glu_gated_glu__prompt_kernel_poll6
sequential_preLN__softmax_full_mha__glu_gated_glu__prompt_kernel_poll6x:
    s_mov_b64 exec, -1
sequential_preLN__softmax_full_mha__glu_gated_glu__prompt_kernel_b5b:
    s_barrier
    s_add_u32 m0, s18, 0
    s_add_u32 s16, s16, 8192
    buffer_load_dwordx4 v4, s[4:7], s16 offen offset:0 sc1 lds
    buffer_load_dwordx4 v4, s[4:7], s16 offen offset:1024 sc1 lds
    s_add_u32 m0, s18, 24576
    s_add_u32 s16, s16, 8192
    buffer_load_dwordx4 v4, s[4:7], s16 offen offset:0 sc1 lds
    buffer_load_dwordx4 v4, s[4:7], s16 offen offset:1024 sc1 lds
    s_add_u32 m0, s18, 49152
    s_add_u32 s16, s16, 8192
    buffer_load_dwordx4 v4, s[4:7], s16 offen offset:0 sc1 lds
    buffer_load_dwordx4 v4, s[4:7], s16 offen offset:1024 sc1 lds
    s_add_u32 m0, s18, 73728
    s_add_u32 s16, s16, 8192
    buffer_load_dwordx4 v4, s[4:7], s16 offen offset:0 sc1 lds
    buffer_load_dwordx4 v4, s[4:7], s16 offen offset:1024 sc1 lds
    s_waitcnt vmcnt(2)
    s_barrier
    ds_read_b128 v[64:67], v24 offset:0
    ds_read_b128 v[68:71], v24 offset:1024
    ds_read_b64_tr_b16 v[96:97], v25 offset:0
    ds_read_b64_tr_b16 v[98:99], v25 offset:4096
    ds_read_b64_tr_b16 v[100:101], v26 offset:0
    ds_read_b64_tr_b16 v[102:103], v26 offset:4096
    ds_read_b64_tr_b16 v[104:105], v25 offset:1024
    ds_read_b64_tr_b16 v[106:107], v25 offset:5120
    ds_read_b64_tr_b16 v[108:109], v26 offset:1024
    ds_read_b64_tr_b16 v[110:111], v26 offset:5120
    ds_read_b128 v[72:75], v24 offset:4096
    ds_read_b128 v[76:79], v24 offset:5120
    ds_read_b64_tr_b16 v[112:113], v25 offset:8192
    ds_read_b64_tr_b16 v[114:115], v25 offset:12288
    ds_read_b64_tr_b16 v[116:117], v26 offset:8192
    ds_read_b64_tr_b16 v[118:119], v26 offset:12288
    ds_read_b64_tr_b16 v[120:121], v25 offset:9216
    ds_read_b64_tr_b16 v[122:123], v25 offset:13312
    ds_read_b64_tr_b16 v[124:125], v26 offset:9216
    ds_read_b64_tr_b16 v[126:127], v26 offset:13312
    s_mov_b32 s20, 4
    s_waitcnt lgkmcnt(0)
sequential_preLN__softmax_full_mha__glu_gated_glu__prompt_kernel_p3loop:
    v_mfma_f32_16x16x32_bf16 v[32:35], v[96:99], v[64:67], v[32:35]
    s_waitcnt vmcnt(12)
    s_barrier
    v_mfma_f32_16x16x32_bf16 v[36:39], v[96:99], v[68:71], v[36:39]
    ds_read_b128 v[80:83], v24 offset:24576
    s_add_u32 m0, s18, 0
    ds_read_b128 v[84:87], v24 offset:25600
    v_mfma_f32_16x16x32_bf16 v[40:43], v[100:103], v[64:67], v[40:43]
    ds_read_b64_tr_b16 v[128:129], v25 offset:24576
    s_add_u32 s16, s16, 8192
    v_mfma_f32_16x16x32_bf16 v[44:47], v[100:103], v[68:71], v[44:47]
    ds_read_b64_tr_b16 v[130:131], v25 offset:28672
    ds_read_b64_tr_b16 v[132:133], v26 offset:24576
    buffer_load_dwordx4 v4, s[4:7], s16 offen offset:0 sc1 lds
    v_mfma_f32_16x16x32_bf16 v[48:51], v[104:107], v[64:67], v[48:51]
    ds_read_b64_tr_b16 v[134:135], v26 offset:28672
    ds_read_b64_tr_b16 v[136:137], v25 offset:25600
    v_mfma_f32_16x16x32_bf16 v[52:55], v[104:107], v[68:71], v[52:55]
    buffer_load_dwordx4 v4, s[4:7], s16 offen offset:1024 sc1 lds
    ds_read_b64_tr_b16 v[138:139], v25 offset:29696
    ds_read_b64_tr_b16 v[140:141], v26 offset:25600
    v_mfma_f32_16x16x32_bf16 v[56:59], v[108:111], v[64:67], v[56:59]
    s_add_u32 m0, s19, 0
    ds_read_b64_tr_b16 v[142:143], v26 offset:29696
    v_mfma_f32_16x16x32_bf16 v[60:63], v[108:111], v[68:71], v[60:63]
    ds_read_b128 v[88:91], v24 offset:28672
    s_add_u32 s17, s17, 131072
    ds_read_b128 v[92:95], v24 offset:29696
    v_mfma_f32_16x16x32_bf16 v[32:35], v[112:115], v[72:75], v[32:35]
    ds_read_b64_tr_b16 v[144:145], v25 offset:32768
    buffer_load_dwordx4 v8, s[8:11], s17 offen offset:0 lds
    v_mfma_f32_16x16x32_bf16 v[36:39], v[112:115], v[76:79], v[36:39]
    ds_read_b64_tr_b16 v[146:147], v25 offset:36864
    ds_read_b64_tr_b16 v[148:149], v26 offset:32768
    buffer_load_dwordx4 v9, s[8:11], s17 offen offset:1024 lds
    v_mfma_f32_16x16x32_bf16 v[40:43], v[116:119], v[72:75], v[40:43]
    ds_read_b64_tr_b16 v[150:151], v26 offset:36864
    ds_read_b64_tr_b16 v[152:153], v25 offset:33792
    v_mfma_f32_16x16x32_bf16 v[44:47], v[116:119], v[76:79], v[44:47]
    buffer_load_dwordx4 v10, s[8:11], s17 offen offset:2048 lds
    ds_read_b64_tr_b16 v[154:155], v25 offset:37888
    ds_read_b64_tr_b16 v[156:157], v26 offset:33792
    v_mfma_f32_16x16x32_bf16 v[48:51], v[120:123], v[72:75], v[48:51]
    buffer_load_dwordx4 v11, s[8:11], s17 offen offset:3072 lds
    ds_read_b64_tr_b16 v[158:159], v26 offset:37888
    v_mfma_f32_16x16x32_bf16 v[52:55], v[120:123], v[76:79], v[52:55]
    v_mfma_f32_16x16x32_bf16 v[56:59], v[124:127], v[72:75], v[56:59]
    v_mfma_f32_16x16x32_bf16 v[60:63], v[124:127], v[76:79], v[60:63]
    s_waitcnt lgkmcnt(0)
    v_mfma_f32_16x16x32_bf16 v[32:35], v[128:131], v[80:83], v[32:35]
    s_waitcnt vmcnt(12)
    s_barrier
    v_mfma_f32_16x16x32_bf16 v[36:39], v[128:131], v[84:87], v[36:39]
    ds_read_b128 v[64:67], v27 offset:0
    s_add_u32 m0, s18, 24576
    ds_read_b128 v[68:71], v27 offset:1024
    v_mfma_f32_16x16x32_bf16 v[40:43], v[132:135], v[80:83], v[40:43]
    ds_read_b64_tr_b16 v[96:97], v28 offset:0
    s_add_u32 s16, s16, 8192
    v_mfma_f32_16x16x32_bf16 v[44:47], v[132:135], v[84:87], v[44:47]
    ds_read_b64_tr_b16 v[98:99], v28 offset:4096
    ds_read_b64_tr_b16 v[100:101], v29 offset:0
    buffer_load_dwordx4 v4, s[4:7], s16 offen offset:0 sc1 lds
    v_mfma_f32_16x16x32_bf16 v[48:51], v[136:139], v[80:83], v[48:51]
    ds_read_b64_tr_b16 v[102:103], v29 offset:4096
    ds_read_b64_tr_b16 v[104:105], v28 offset:1024
    v_mfma_f32_16x16x32_bf16 v[52:55], v[136:139], v[84:87], v[52:55]
    buffer_load_dwordx4 v4, s[4:7], s16 offen offset:1024 sc1 lds
    ds_read_b64_tr_b16 v[106:107], v28 offset:5120
    ds_read_b64_tr_b16 v[108:109], v29 offset:1024
    v_mfma_f32_16x16x32_bf16 v[56:59], v[140:143], v[80:83], v[56:59]
    s_add_u32 m0, s19, 24576
    ds_read_b64_tr_b16 v[110:111], v29 offset:5120
    v_mfma_f32_16x16x32_bf16 v[60:63], v[140:143], v[84:87], v[60:63]
    ds_read_b128 v[72:75], v27 offset:4096
    s_add_u32 s17, s17, 131072
    ds_read_b128 v[76:79], v27 offset:5120
    v_mfma_f32_16x16x32_bf16 v[32:35], v[144:147], v[88:91], v[32:35]
    ds_read_b64_tr_b16 v[112:113], v28 offset:8192
    buffer_load_dwordx4 v8, s[8:11], s17 offen offset:0 lds
    v_mfma_f32_16x16x32_bf16 v[36:39], v[144:147], v[92:95], v[36:39]
    ds_read_b64_tr_b16 v[114:115], v28 offset:12288
    ds_read_b64_tr_b16 v[116:117], v29 offset:8192
    buffer_load_dwordx4 v9, s[8:11], s17 offen offset:1024 lds
    v_mfma_f32_16x16x32_bf16 v[40:43], v[148:151], v[88:91], v[40:43]
    ds_read_b64_tr_b16 v[118:119], v29 offset:12288
    ds_read_b64_tr_b16 v[120:121], v28 offset:9216
    v_mfma_f32_16x16x32_bf16 v[44:47], v[148:151], v[92:95], v[44:47]
    buffer_load_dwordx4 v10, s[8:11], s17 offen offset:2048 lds
    ds_read_b64_tr_b16 v[122:123], v28 offset:13312
    ds_read_b64_tr_b16 v[124:125], v29 offset:9216
    v_mfma_f32_16x16x32_bf16 v[48:51], v[152:155], v[88:91], v[48:51]
    buffer_load_dwordx4 v11, s[8:11], s17 offen offset:3072 lds
    ds_read_b64_tr_b16 v[126:127], v29 offset:13312
    v_mfma_f32_16x16x32_bf16 v[52:55], v[152:155], v[92:95], v[52:55]
    v_mfma_f32_16x16x32_bf16 v[56:59], v[156:159], v[88:91], v[56:59]
    v_mfma_f32_16x16x32_bf16 v[60:63], v[156:159], v[92:95], v[60:63]
    s_waitcnt lgkmcnt(0)
    v_mfma_f32_16x16x32_bf16 v[32:35], v[96:99], v[64:67], v[32:35]
    s_waitcnt vmcnt(12)
    s_barrier
    v_mfma_f32_16x16x32_bf16 v[36:39], v[96:99], v[68:71], v[36:39]
    ds_read_b128 v[80:83], v27 offset:24576
    s_add_u32 m0, s18, 49152
    ds_read_b128 v[84:87], v27 offset:25600
    v_mfma_f32_16x16x32_bf16 v[40:43], v[100:103], v[64:67], v[40:43]
    ds_read_b64_tr_b16 v[128:129], v28 offset:24576
    s_add_u32 s16, s16, 8192
    v_mfma_f32_16x16x32_bf16 v[44:47], v[100:103], v[68:71], v[44:47]
    ds_read_b64_tr_b16 v[130:131], v28 offset:28672
    ds_read_b64_tr_b16 v[132:133], v29 offset:24576
    buffer_load_dwordx4 v4, s[4:7], s16 offen offset:0 sc1 lds
    v_mfma_f32_16x16x32_bf16 v[48:51], v[104:107], v[64:67], v[48:51]
    ds_read_b64_tr_b16 v[134:135], v29 offset:28672
    ds_read_b64_tr_b16 v[136:137], v28 offset:25600
    v_mfma_f32_16x16x32_bf16 v[52:55], v[104:107], v[68:71], v[52:55]
    buffer_load_dwordx4 v4, s[4:7], s16 offen offset:1024 sc1 lds
    ds_read_b64_tr_b16 v[138:139], v28 offset:29696
    ds_read_b64_tr_b16 v[140:141], v29 offset:25600
    v_mfma_f32_16x16x32_bf16 v[56:59], v[108:111], v[64:67], v[56:59]
    s_add_u32 m0, s19, 49152
    ds_read_b64_tr_b16 v[142:143], v29 offset:29696
    v_mfma_f32_16x16x32_bf16 v[60:63], v[108:111], v[68:71], v[60:63]
    ds_read_b128 v[88:91], v27 offset:28672
    s_add_u32 s17, s17, 131072
    ds_read_b128 v[92:95], v27 offset:29696
    v_mfma_f32_16x16x32_bf16 v[32:35], v[112:115], v[72:75], v[32:35]
    ds_read_b64_tr_b16 v[144:145], v28 offset:32768
    buffer_load_dwordx4 v8, s[8:11], s17 offen offset:0 lds
    v_mfma_f32_16x16x32_bf16 v[36:39], v[112:115], v[76:79], v[36:39]
    ds_read_b64_tr_b16 v[146:147], v28 offset:36864
    ds_read_b64_tr_b16 v[148:149], v29 offset:32768
    buffer_load_dwordx4 v9, s[8:11], s17 offen offset:1024 lds
    v_mfma_f32_16x16x32_bf16 v[40:43], v[116:119], v[72:75], v[40:43]
    ds_read_b64_tr_b16 v[150:151], v29 offset:36864
    ds_read_b64_tr_b16 v[152:153], v28 offset:33792
    v_mfma_f32_16x16x32_bf16 v[44:47], v[116:119], v[76:79], v[44:47]
    buffer_load_dwordx4 v10, s[8:11], s17 offen offset:2048 lds
    ds_read_b64_tr_b16 v[154:155], v28 offset:37888
    ds_read_b64_tr_b16 v[156:157], v29 offset:33792
    v_mfma_f32_16x16x32_bf16 v[48:51], v[120:123], v[72:75], v[48:51]
    buffer_load_dwordx4 v11, s[8:11], s17 offen offset:3072 lds
    ds_read_b64_tr_b16 v[158:159], v29 offset:37888
    v_mfma_f32_16x16x32_bf16 v[52:55], v[120:123], v[76:79], v[52:55]
    v_mfma_f32_16x16x32_bf16 v[56:59], v[124:127], v[72:75], v[56:59]
    v_mfma_f32_16x16x32_bf16 v[60:63], v[124:127], v[76:79], v[60:63]
    s_waitcnt lgkmcnt(0)
    v_mfma_f32_16x16x32_bf16 v[32:35], v[128:131], v[80:83], v[32:35]
    s_waitcnt vmcnt(12)
    s_barrier
    v_mfma_f32_16x16x32_bf16 v[36:39], v[128:131], v[84:87], v[36:39]
    ds_read_b128 v[64:67], v24 offset:0
    s_add_u32 m0, s18, 73728
    ds_read_b128 v[68:71], v24 offset:1024
    v_mfma_f32_16x16x32_bf16 v[40:43], v[132:135], v[80:83], v[40:43]
    ds_read_b64_tr_b16 v[96:97], v25 offset:0
    s_add_u32 s16, s16, 8192
    v_mfma_f32_16x16x32_bf16 v[44:47], v[132:135], v[84:87], v[44:47]
    ds_read_b64_tr_b16 v[98:99], v25 offset:4096
    ds_read_b64_tr_b16 v[100:101], v26 offset:0
    buffer_load_dwordx4 v4, s[4:7], s16 offen offset:0 sc1 lds
    v_mfma_f32_16x16x32_bf16 v[48:51], v[136:139], v[80:83], v[48:51]
    ds_read_b64_tr_b16 v[102:103], v26 offset:4096
    ds_read_b64_tr_b16 v[104:105], v25 offset:1024
    v_mfma_f32_16x16x32_bf16 v[52:55], v[136:139], v[84:87], v[52:55]
    buffer_load_dwordx4 v4, s[4:7], s16 offen offset:1024 sc1 lds
    ds_read_b64_tr_b16 v[106:107], v25 offset:5120
    ds_read_b64_tr_b16 v[108:109], v26 offset:1024
    v_mfma_f32_16x16x32_bf16 v[56:59], v[140:143], v[80:83], v[56:59]
    s_add_u32 m0, s19, 73728
    ds_read_b64_tr_b16 v[110:111], v26 offset:5120
    v_mfma_f32_16x16x32_bf16 v[60:63], v[140:143], v[84:87], v[60:63]
    ds_read_b128 v[72:75], v24 offset:4096
    s_add_u32 s17, s17, 131072
    ds_read_b128 v[76:79], v24 offset:5120
    v_mfma_f32_16x16x32_bf16 v[32:35], v[144:147], v[88:91], v[32:35]
    ds_read_b64_tr_b16 v[112:113], v25 offset:8192
    buffer_load_dwordx4 v8, s[8:11], s17 offen offset:0 lds
    v_mfma_f32_16x16x32_bf16 v[36:39], v[144:147], v[92:95], v[36:39]
    ds_read_b64_tr_b16 v[114:115], v25 offset:12288
    ds_read_b64_tr_b16 v[116:117], v26 offset:8192
    buffer_load_dwordx4 v9, s[8:11], s17 offen offset:1024 lds
    v_mfma_f32_16x16x32_bf16 v[40:43], v[148:151], v[88:91], v[40:43]
    ds_read_b64_tr_b16 v[118:119], v26 offset:12288
    ds_read_b64_tr_b16 v[120:121], v25 offset:9216
    v_mfma_f32_16x16x32_bf16 v[44:47], v[148:151], v[92:95], v[44:47]
    buffer_load_dwordx4 v10, s[8:11], s17 offen offset:2048 lds
    ds_read_b64_tr_b16 v[122:123], v25 offset:13312
    ds_read_b64_tr_b16 v[124:125], v26 offset:9216
    v_mfma_f32_16x16x32_bf16 v[48:51], v[152:155], v[88:91], v[48:51]
    buffer_load_dwordx4 v11, s[8:11], s17 offen offset:3072 lds
    ds_read_b64_tr_b16 v[126:127], v26 offset:13312
    v_mfma_f32_16x16x32_bf16 v[52:55], v[152:155], v[92:95], v[52:55]
    s_sub_u32 s20, s20, 1
    v_mfma_f32_16x16x32_bf16 v[56:59], v[156:159], v[88:91], v[56:59]
    s_cmp_lg_u32 s20, 0
    v_mfma_f32_16x16x32_bf16 v[60:63], v[156:159], v[92:95], v[60:63]
    s_waitcnt lgkmcnt(0)
    s_cbranch_scc1 sequential_preLN__softmax_full_mha__glu_gated_glu__prompt_kernel_p3loop
    s_waitcnt vmcnt(0)
    s_barrier
    s_nop 5
    v_mov_b32 v20, 0
    v_mov_b32 v21, 0
    v_mov_b32 v22, 0
    v_mov_b32 v23, 0
    v_permlane16_swap_b32 v160, v162
    v_permlane16_swap_b32 v161, v163
    v_permlane16_swap_b32 v164, v166
    v_permlane16_swap_b32 v165, v167
    v_permlane16_swap_b32 v168, v170
    v_permlane16_swap_b32 v169, v171
    v_permlane16_swap_b32 v172, v174
    v_permlane16_swap_b32 v173, v175
    v_lshlrev_b32 v18, 16, v160
    v_and_b32 v19, 0xffff0000, v160
    v_add_f32 v32, v32, v18
    v_add_f32 v33, v33, v19
    v_lshlrev_b32 v18, 16, v161
    v_and_b32 v19, 0xffff0000, v161
    v_add_f32 v34, v34, v18
    v_add_f32 v35, v35, v19
    v_lshlrev_b32 v18, 16, v162
    v_and_b32 v19, 0xffff0000, v162
    v_add_f32 v40, v40, v18
    v_add_f32 v41, v41, v19
    v_lshlrev_b32 v18, 16, v163
    v_and_b32 v19, 0xffff0000, v163
    v_add_f32 v42, v42, v18
    v_add_f32 v43, v43, v19
    v_cvt_pk_bf16_f32 v64, v32, v33
    v_cvt_pk_bf16_f32 v65, v34, v35
    v_cvt_pk_bf16_f32 v66, v40, v41
    v_cvt_pk_bf16_f32 v67, v42, v43
    buffer_store_dwordx4 v[64:67], v4, s[12:15], s50 offen offset:0 sc1
    v_accvgpr_write_b32 a184, v64
    v_accvgpr_write_b32 a185, v65
    v_accvgpr_write_b32 a186, v66
    v_accvgpr_write_b32 a187, v67
    v_lshlrev_b32 v18, 16, v64
    v_and_b32 v19, 0xffff0000, v64
    v_add_f32 v20, v20, v18
    v_fmac_f32 v21, v18, v18
    v_add_f32 v20, v20, v19
    v_fmac_f32 v21, v19, v19
    v_lshlrev_b32 v18, 16, v65
    v_and_b32 v19, 0xffff0000, v65
    v_add_f32 v20, v20, v18
    v_fmac_f32 v21, v18, v18
    v_add_f32 v20, v20, v19
    v_fmac_f32 v21, v19, v19
    v_lshlrev_b32 v18, 16, v66
    v_and_b32 v19, 0xffff0000, v66
    v_add_f32 v20, v20, v18
    v_fmac_f32 v21, v18, v18
    v_add_f32 v20, v20, v19
    v_fmac_f32 v21, v19, v19
    v_lshlrev_b32 v18, 16, v67
    v_and_b32 v19, 0xffff0000, v67
    v_add_f32 v20, v20, v18
    v_fmac_f32 v21, v18, v18
    v_add_f32 v20, v20, v19
    v_fmac_f32 v21, v19, v19
    v_lshlrev_b32 v18, 16, v164
    v_and_b32 v19, 0xffff0000, v164
    v_add_f32 v36, v36, v18
    v_add_f32 v37, v37, v19
    v_lshlrev_b32 v18, 16, v165
    v_and_b32 v19, 0xffff0000, v165
    v_add_f32 v38, v38, v18
    v_add_f32 v39, v39, v19
    v_lshlrev_b32 v18, 16, v166
    v_and_b32 v19, 0xffff0000, v166
    v_add_f32 v44, v44, v18
    v_add_f32 v45, v45, v19
    v_lshlrev_b32 v18, 16, v167
    v_and_b32 v19, 0xffff0000, v167
    v_add_f32 v46, v46, v18
    v_add_f32 v47, v47, v19
    v_cvt_pk_bf16_f32 v68, v36, v37
    v_cvt_pk_bf16_f32 v69, v38, v39
    v_cvt_pk_bf16_f32 v70, v44, v45
    v_cvt_pk_bf16_f32 v71, v46, v47
    buffer_store_dwordx4 v[68:71], v4, s[12:15], s50 offen offset:1024 sc1
    v_accvgpr_write_b32 a188, v68
    v_accvgpr_write_b32 a189, v69
    v_accvgpr_write_b32 a190, v70
    v_accvgpr_write_b32 a191, v71
    v_lshlrev_b32 v18, 16, v68
    v_and_b32 v19, 0xffff0000, v68
    v_add_f32 v22, v22, v18
    v_fmac_f32 v23, v18, v18
    v_add_f32 v22, v22, v19
    v_fmac_f32 v23, v19, v19
    v_lshlrev_b32 v18, 16, v69
    v_and_b32 v19, 0xffff0000, v69
    v_add_f32 v22, v22, v18
    v_fmac_f32 v23, v18, v18
    v_add_f32 v22, v22, v19
    v_fmac_f32 v23, v19, v19
    v_lshlrev_b32 v18, 16, v70
    v_and_b32 v19, 0xffff0000, v70
    v_add_f32 v22, v22, v18
    v_fmac_f32 v23, v18, v18
    v_add_f32 v22, v22, v19
    v_fmac_f32 v23, v19, v19
    v_lshlrev_b32 v18, 16, v71
    v_and_b32 v19, 0xffff0000, v71
    v_add_f32 v22, v22, v18
    v_fmac_f32 v23, v18, v18
    v_add_f32 v22, v22, v19
    v_fmac_f32 v23, v19, v19
    v_lshlrev_b32 v18, 16, v168
    v_and_b32 v19, 0xffff0000, v168
    v_add_f32 v48, v48, v18
    v_add_f32 v49, v49, v19
    v_lshlrev_b32 v18, 16, v169
    v_and_b32 v19, 0xffff0000, v169
    v_add_f32 v50, v50, v18
    v_add_f32 v51, v51, v19
    v_lshlrev_b32 v18, 16, v170
    v_and_b32 v19, 0xffff0000, v170
    v_add_f32 v56, v56, v18
    v_add_f32 v57, v57, v19
    v_lshlrev_b32 v18, 16, v171
    v_and_b32 v19, 0xffff0000, v171
    v_add_f32 v58, v58, v18
    v_add_f32 v59, v59, v19
    v_cvt_pk_bf16_f32 v72, v48, v49
    v_cvt_pk_bf16_f32 v73, v50, v51
    v_cvt_pk_bf16_f32 v74, v56, v57
    v_cvt_pk_bf16_f32 v75, v58, v59
    buffer_store_dwordx4 v[72:75], v4, s[12:15], s51 offen offset:0 sc1
    v_accvgpr_write_b32 a192, v72
    v_accvgpr_write_b32 a193, v73
    v_accvgpr_write_b32 a194, v74
    v_accvgpr_write_b32 a195, v75
    v_lshlrev_b32 v18, 16, v72
    v_and_b32 v19, 0xffff0000, v72
    v_add_f32 v20, v20, v18
    v_fmac_f32 v21, v18, v18
    v_add_f32 v20, v20, v19
    v_fmac_f32 v21, v19, v19
    v_lshlrev_b32 v18, 16, v73
    v_and_b32 v19, 0xffff0000, v73
    v_add_f32 v20, v20, v18
    v_fmac_f32 v21, v18, v18
    v_add_f32 v20, v20, v19
    v_fmac_f32 v21, v19, v19
    v_lshlrev_b32 v18, 16, v74
    v_and_b32 v19, 0xffff0000, v74
    v_add_f32 v20, v20, v18
    v_fmac_f32 v21, v18, v18
    v_add_f32 v20, v20, v19
    v_fmac_f32 v21, v19, v19
    v_lshlrev_b32 v18, 16, v75
    v_and_b32 v19, 0xffff0000, v75
    v_add_f32 v20, v20, v18
    v_fmac_f32 v21, v18, v18
    v_add_f32 v20, v20, v19
    v_fmac_f32 v21, v19, v19
    v_lshlrev_b32 v18, 16, v172
    v_and_b32 v19, 0xffff0000, v172
    v_add_f32 v52, v52, v18
    v_add_f32 v53, v53, v19
    v_lshlrev_b32 v18, 16, v173
    v_and_b32 v19, 0xffff0000, v173
    v_add_f32 v54, v54, v18
    v_add_f32 v55, v55, v19
    v_lshlrev_b32 v18, 16, v174
    v_and_b32 v19, 0xffff0000, v174
    v_add_f32 v60, v60, v18
    v_add_f32 v61, v61, v19
    v_lshlrev_b32 v18, 16, v175
    v_and_b32 v19, 0xffff0000, v175
    v_add_f32 v62, v62, v18
    v_add_f32 v63, v63, v19
    v_cvt_pk_bf16_f32 v76, v52, v53
    v_cvt_pk_bf16_f32 v77, v54, v55
    v_cvt_pk_bf16_f32 v78, v60, v61
    v_cvt_pk_bf16_f32 v79, v62, v63
    buffer_store_dwordx4 v[76:79], v4, s[12:15], s51 offen offset:1024 sc1
    v_accvgpr_write_b32 a196, v76
    v_accvgpr_write_b32 a197, v77
    v_accvgpr_write_b32 a198, v78
    v_accvgpr_write_b32 a199, v79
    v_lshlrev_b32 v18, 16, v76
    v_and_b32 v19, 0xffff0000, v76
    v_add_f32 v22, v22, v18
    v_fmac_f32 v23, v18, v18
    v_add_f32 v22, v22, v19
    v_fmac_f32 v23, v19, v19
    v_lshlrev_b32 v18, 16, v77
    v_and_b32 v19, 0xffff0000, v77
    v_add_f32 v22, v22, v18
    v_fmac_f32 v23, v18, v18
    v_add_f32 v22, v22, v19
    v_fmac_f32 v23, v19, v19
    v_lshlrev_b32 v18, 16, v78
    v_and_b32 v19, 0xffff0000, v78
    v_add_f32 v22, v22, v18
    v_fmac_f32 v23, v18, v18
    v_add_f32 v22, v22, v19
    v_fmac_f32 v23, v19, v19
    v_lshlrev_b32 v18, 16, v79
    v_and_b32 v19, 0xffff0000, v79
    v_add_f32 v22, v22, v18
    v_fmac_f32 v23, v18, v18
    v_add_f32 v22, v22, v19
    v_fmac_f32 v23, v19, v19
    v_mov_b32 v24, v20
    v_mov_b32 v25, v21
    v_mov_b32 v26, v22
    v_mov_b32 v27, v23
    s_nop 1
    v_permlane16_swap_b32 v20, v24
    v_permlane16_swap_b32 v21, v25
    v_permlane16_swap_b32 v22, v26
    v_permlane16_swap_b32 v23, v27
    s_nop 1
    v_add_f32 v20, v20, v24
    v_add_f32 v21, v21, v25
    v_add_f32 v22, v22, v26
    v_add_f32 v23, v23, v27
    v_mov_b32 v24, v20
    v_mov_b32 v25, v21
    v_mov_b32 v26, v22
    v_mov_b32 v27, v23
    s_nop 1
    v_permlane32_swap_b32 v20, v24
    v_permlane32_swap_b32 v21, v25
    v_permlane32_swap_b32 v22, v26
    v_permlane32_swap_b32 v23, v27
    s_nop 1
    v_add_f32 v20, v20, v24
    v_add_f32 v21, v21, v25
    v_add_f32 v22, v22, v26
    v_add_f32 v23, v23, v27
    v_lshlrev_b32 v17, 3, v3
    s_lshl_b32 s45, s40, 13
    s_lshl_b32 s46, s41, 10
    s_add_u32 s45, s45, s46
    s_lshl_b32 s46, s44, 9
    s_add_u32 s45, s45, s46
    s_lshl_b32 s46, s43, 8
    s_add_u32 s45, s45, s46
    s_mov_b64 exec, 0xffff
    buffer_store_dwordx2 v[20:21], v17, s[56:59], s45 offen sc1
    buffer_store_dwordx2 v[22:23], v17, s[56:59], s45 offen offset:128 sc1
    s_mov_b64 exec, -1
    s_lshr_b32 s92, s40, 2
    s_add_u32 s92, s92, 40
    v_lshrrev_b32 v2, 4, v1
    v_and_b32 v3, 15, v1
    s_and_b32 s40, s38, 1
    s_lshl_b32 s40, s40, 2
    s_and_b32 s45, s39, 3
    s_add_u32 s40, s40, s45
    s_lshr_b32 s41, s38, 1
    s_lshl_b32 s41, s41, 3
    s_lshr_b32 s45, s39, 2
    s_add_u32 s41, s41, s45
    s_lshr_b32 s43, s42, 0
    s_and_b32 s44, s42, 0
    v_lshlrev_b32 v4, 4, v1
    s_lshr_b32 s45, s42, 0
    s_lshl_b32 s46, s40, 2
    s_add_u32 s45, s45, s46
    s_mul_i32 s31, s45, 131072
    s_and_b32 s46, s42, 0
    s_mul_i32 s16, s46, 4096
    s_mul_i32 s18, s42, 4096
    s_lshl_b32 s45, s43, 12
    v_add_u32 v12, s45, v4
    s_and_b32 s45, s42, 1
    s_mul_i32 s45, s45, 192
    v_add_u32 v20, s45, v1
    s_mov_b32 s46, 0x12492493
    v_add_u32 v21, 0, v20
    v_mul_hi_u32 v22, v21, s46
    v_mul_u32_u24 v23, 14, v22
    v_sub_u32 v21, v21, v23
    v_mul_u32_u24 v22, 7168, v22
    v_lshl_add_u32 v22, v21, 4, v22
    v_add_u32 v8, 4096, v22
    v_add_u32 v21, 64, v20
    v_mul_hi_u32 v22, v21, s46
    v_mul_u32_u24 v23, 14, v22
    v_sub_u32 v21, v21, v23
    v_mul_u32_u24 v22, 7168, v22
    v_lshl_add_u32 v22, v21, 4, v22
    v_add_u32 v9, 3072, v22
    v_add_u32 v21, 128, v20
    v_mul_hi_u32 v22, v21, s46
    v_mul_u32_u24 v23, 14, v22
    v_sub_u32 v21, v21, v23
    v_mul_u32_u24 v22, 7168, v22
    v_lshl_add_u32 v22, v21, 4, v22
    v_add_u32 v10, 2048, v22
    v_add_u32 v21, 192, v20
    v_mul_hi_u32 v22, v21, s46
    v_mul_u32_u24 v23, 14, v22
    v_sub_u32 v21, v21, v23
    v_mul_u32_u24 v22, 7168, v22
    v_lshl_add_u32 v22, v21, 4, v22
    v_add_u32 v11, 1024, v22
    s_mul_i32 s17, s41, 224
    s_lshr_b32 s46, s42, 1
    s_mul_i32 s46, s46, 7168
    s_lshl_b32 s45, s45, 4
    s_add_u32 s19, s45, s46
    s_add_u32 s19, s19, 16384
    s_sub_u32 s17, s17, 229376
    s_sub_u32 s16, s16, 4096
    s_cmp_ge_u32 s42, 2
    s_cselect_b32 s34, s74, s72
    s_cselect_b32 s35, s75, s73
    s_add_u32 s4, s82, 20971520
    s_addc_u32 s5, s83, 0
    s_and_b32 s5, s5, 0xffff
    s_mov_b32 s6, 4194304
    s_mov_b32 s7, 0x20000
    s_sub_u32 s8, s34, 4096
    s_subb_u32 s9, s35, 0
    s_and_b32 s9, s9, 0xffff
    s_mov_b32 s10, 7344128
    s_mov_b32 s11, 0x20000
    s_add_u32 s12, s82, 25165824
    s_addc_u32 s13, s83, 0
    s_and_b32 s13, s13, 0xffff
    s_mov_b32 s14, 14680064
    s_mov_b32 s15, 0x20000
    s_add_u32 s52, s82, 41943040
    s_addc_u32 s53, s83, 0
    s_and_b32 s53, s53, 0xffff
    s_mov_b32 s54, 262144
    s_mov_b32 s55, 0x20000
    s_add_u32 s56, s82, 42991616
    s_addc_u32 s57, s83, 0
    s_and_b32 s57, s57, 0xffff
    s_mov_b32 s58, 229376
    s_mov_b32 s59, 0x20000
    s_add_u32 s4, s4, s31
    s_addc_u32 s5, s5, 0
    s_mov_b32 s6, 131072
    s_waitcnt vmcnt(0)
    s_barrier
    s_cmp_lg_u32 s42, 0
    s_cbranch_scc1 sequential_preLN__softmax_full_mha__glu_gated_glu__prompt_kernel_b7a
    s_lshl_b32 s92, s92, 8
    v_mov_b32 v30, s92
    v_mov_b32 v31, 1
    s_mov_b64 exec, 1
    buffer_atomic_add v31, v30, s[84:87], 0 offen sc1
    s_mov_b64 exec, -1
sequential_preLN__softmax_full_mha__glu_gated_glu__prompt_kernel_b7a:
    s_add_u32 m0, s19, 0
    s_add_u32 s17, s17, 229376
    buffer_load_dwordx4 v8, s[8:11], s17 offen offset:0 lds
    buffer_load_dwordx4 v9, s[8:11], s17 offen offset:1024 lds
    buffer_load_dwordx4 v10, s[8:11], s17 offen offset:2048 lds
    buffer_load_dwordx4 v11, s[8:11], s17 offen offset:3072 lds
    s_add_u32 m0, s19, 30720
    s_add_u32 s17, s17, 229376
    buffer_load_dwordx4 v8, s[8:11], s17 offen offset:0 lds
    buffer_load_dwordx4 v9, s[8:11], s17 offen offset:1024 lds
    buffer_load_dwordx4 v10, s[8:11], s17 offen offset:2048 lds
    buffer_load_dwordx4 v11, s[8:11], s17 offen offset:3072 lds
    s_add_u32 m0, s19, 61440
    s_add_u32 s17, s17, 229376
    buffer_load_dwordx4 v8, s[8:11], s17 offen offset:0 lds
    buffer_load_dwordx4 v9, s[8:11], s17 offen offset:1024 lds
    buffer_load_dwordx4 v10, s[8:11], s17 offen offset:2048 lds
    buffer_load_dwordx4 v11, s[8:11], s17 offen offset:3072 lds
    v_lshrrev_b32 v20, 2, v1
    v_mul_u32_u24 v20, 224, v20
    v_and_b32 v21, 3, v1
    v_lshl_add_u32 v20, v21, 3, v20
    v_add_u32 v13, 16384, v20
    v_add_u32 v14, 61440, v12
    v_add_u32 v15, 61440, v13
    v_mov_b32 v32, 0
    v_mov_b32 v33, 0
    v_mov_b32 v34, 0
    v_mov_b32 v35, 0
    v_mov_b32 v36, 0
    v_mov_b32 v37, 0
    v_mov_b32 v38, 0
    v_mov_b32 v39, 0
    v_mov_b32 v40, 0
    v_mov_b32 v41, 0
    v_mov_b32 v42, 0
    v_mov_b32 v43, 0
    v_mov_b32 v44, 0
    v_mov_b32 v45, 0
    v_mov_b32 v46, 0
    v_mov_b32 v47, 0
    v_mov_b32 v48, 0
    v_mov_b32 v49, 0
    v_mov_b32 v50, 0
    v_mov_b32 v51, 0
    v_mov_b32 v52, 0
    v_mov_b32 v53, 0
    v_mov_b32 v54, 0
    v_mov_b32 v55, 0
    v_mov_b32 v56, 0
    v_mov_b32 v57, 0
    v_mov_b32 v58, 0
    v_mov_b32 v59, 0
    v_mov_b32 v60, 0
    v_mov_b32 v61, 0
    v_mov_b32 v62, 0
    v_mov_b32 v63, 0
    v_mov_b32 v64, 0
    v_mov_b32 v65, 0
    v_mov_b32 v66, 0
    v_mov_b32 v67, 0
    v_mov_b32 v68, 0
    v_mov_b32 v69, 0
    v_mov_b32 v70, 0
    v_mov_b32 v71, 0
    v_mov_b32 v72, 0
    v_mov_b32 v73, 0
    v_mov_b32 v74, 0
    v_mov_b32 v75, 0
    v_mov_b32 v76, 0
    v_mov_b32 v77, 0
    v_mov_b32 v78, 0
    v_mov_b32 v79, 0
    v_mov_b32 v80, 0
    v_mov_b32 v81, 0
    v_mov_b32 v82, 0
    v_mov_b32 v83, 0
    v_mov_b32 v84, 0
    v_mov_b32 v85, 0
    v_mov_b32 v86, 0
    v_mov_b32 v87, 0
    v_mov_b32 v88, 0
    v_mov_b32 v89, 0
    v_mov_b32 v90, 0
    v_mov_b32 v91, 0
    v_mov_b32 v92, 0
    v_mov_b32 v93, 0
    v_mov_b32 v94, 0
    v_mov_b32 v95, 0
    v_mov_b32 v96, 0
    v_mov_b32 v97, 0
    v_mov_b32 v98, 0
    v_mov_b32 v99, 0
    v_mov_b32 v100, 0
    v_mov_b32 v101, 0
    v_mov_b32 v102, 0
    v_mov_b32 v103, 0
    v_mov_b32 v104, 0
    v_mov_b32 v105, 0
    v_mov_b32 v106, 0
    v_mov_b32 v107, 0
    v_mov_b32 v108, 0
    v_mov_b32 v109, 0
    v_mov_b32 v110, 0
    v_mov_b32 v111, 0
    v_mov_b32 v112, 0
    v_mov_b32 v113, 0
    v_mov_b32 v114, 0
    v_mov_b32 v115, 0
    v_mov_b32 v116, 0
    v_mov_b32 v117, 0
    v_mov_b32 v118, 0
    v_mov_b32 v119, 0
    v_mov_b32 v120, 0
    v_mov_b32 v121, 0
    v_mov_b32 v122, 0
    v_mov_b32 v123, 0
    v_mov_b32 v124, 0
    v_mov_b32 v125, 0
    v_mov_b32 v126, 0
    v_mov_b32 v127, 0
    v_mov_b32 v128, 0
    v_mov_b32 v129, 0
    v_mov_b32 v130, 0
    v_mov_b32 v131, 0
    v_mov_b32 v132, 0
    v_mov_b32 v133, 0
    v_mov_b32 v134, 0
    v_mov_b32 v135, 0
    v_mov_b32 v136, 0
    v_mov_b32 v137, 0
    v_mov_b32 v138, 0
    v_mov_b32 v139, 0
    v_mov_b32 v140, 0
    v_mov_b32 v141, 0
    v_mov_b32 v142, 0
    v_mov_b32 v143, 0
    v_mov_b32 v144, 0
    v_mov_b32 v145, 0
    v_mov_b32 v146, 0
    v_mov_b32 v147, 0
    v_mov_b32 v148, 0
    v_mov_b32 v149, 0
    v_mov_b32 v150, 0
    v_mov_b32 v151, 0
    v_mov_b32 v152, 0
    v_mov_b32 v153, 0
    v_mov_b32 v154, 0
    v_mov_b32 v155, 0
    v_mov_b32 v156, 0
    v_mov_b32 v157, 0
    v_mov_b32 v158, 0
    v_mov_b32 v159, 0
    v_mov_b32 v160, 0
    v_mov_b32 v161, 0
    v_mov_b32 v162, 0
    v_mov_b32 v163, 0
    v_mov_b32 v164, 0
    v_mov_b32 v165, 0
    v_mov_b32 v166, 0
    v_mov_b32 v167, 0
    v_mov_b32 v168, 0
    v_mov_b32 v169, 0
    v_mov_b32 v170, 0
    v_mov_b32 v171, 0
    v_mov_b32 v172, 0
    v_mov_b32 v173, 0
    v_mov_b32 v174, 0
    v_mov_b32 v175, 0
    v_mov_b32 v176, 0
    v_mov_b32 v177, 0
    v_mov_b32 v178, 0
    v_mov_b32 v179, 0
    v_mov_b32 v180, 0
    v_mov_b32 v181, 0
    v_mov_b32 v182, 0
    v_mov_b32 v183, 0
    v_mov_b32 v184, 0
    v_mov_b32 v185, 0
    v_mov_b32 v186, 0
    v_mov_b32 v187, 0
    v_mov_b32 v188, 0
    v_mov_b32 v189, 0
    v_mov_b32 v190, 0
    v_mov_b32 v191, 0
    v_mov_b32 v192, 0
    v_mov_b32 v193, 0
    v_mov_b32 v194, 0
    v_mov_b32 v195, 0
    v_mov_b32 v196, 0
    v_mov_b32 v197, 0
    v_mov_b32 v198, 0
    v_mov_b32 v199, 0
    v_mov_b32 v200, 0
    v_mov_b32 v201, 0
    v_mov_b32 v202, 0
    v_mov_b32 v203, 0
    v_mov_b32 v204, 0
    v_mov_b32 v205, 0
    v_mov_b32 v206, 0
    v_mov_b32 v207, 0
    v_mov_b32 v208, 0
    v_mov_b32 v209, 0
    v_mov_b32 v210, 0
    v_mov_b32 v211, 0
    v_mov_b32 v212, 0
    v_mov_b32 v213, 0
    v_mov_b32 v214, 0
    v_mov_b32 v215, 0
    v_mov_b32 v216, 0
    v_mov_b32 v217, 0
    v_mov_b32 v218, 0
    v_mov_b32 v219, 0
    v_mov_b32 v220, 0
    v_mov_b32 v221, 0
    v_mov_b32 v222, 0
    v_mov_b32 v223, 0
    v_mov_b32 v224, 0
    v_mov_b32 v225, 0
    v_mov_b32 v226, 0
    v_mov_b32 v227, 0
    v_mov_b32 v228, 0
    v_mov_b32 v229, 0
    v_mov_b32 v230, 0
    v_mov_b32 v231, 0
    v_mov_b32 v232, 0
    v_mov_b32 v233, 0
    v_mov_b32 v234, 0
    v_mov_b32 v235, 0
    v_mov_b32 v236, 0
    v_mov_b32 v237, 0
    v_mov_b32 v238, 0
    v_mov_b32 v239, 0
    v_mov_b32 v240, 0
    v_mov_b32 v241, 0
    v_mov_b32 v242, 0
    v_mov_b32 v243, 0
    v_mov_b32 v244, 0
    v_mov_b32 v245, 0
    v_mov_b32 v246, 0
    v_mov_b32 v247, 0
    v_mov_b32 v248, 0
    v_mov_b32 v249, 0
    v_mov_b32 v250, 0
    v_mov_b32 v251, 0
    v_mov_b32 v252, 0
    v_mov_b32 v253, 0
    v_mov_b32 v254, 0
    v_mov_b32 v255, 0
    s_cmp_lg_u32 s42, 0
    s_cbranch_scc1 sequential_preLN__softmax_full_mha__glu_gated_glu__prompt_kernel_b7b
    s_add_u32 s45, s40, 40
    v_add_u32 v30, 32, v1
    v_mov_b32 v31, s45
    v_cmp_eq_u32 vcc, 8, v1
    s_nop 1
    v_cndmask_b32 v30, v30, v31, vcc
    v_lshlrev_b32 v30, 8, v30
    s_mov_b64 exec, 511
    s_mov_b32 s45, 0x20000
sequential_preLN__softmax_full_mha__glu_gated_glu__prompt_kernel_poll8:
    buffer_load_dword v31, v30, s[84:87], 0 offen sc1
    s_sub_u32 s45, s45, 1
    s_cbranch_scc1 sequential_preLN__softmax_full_mha__glu_gated_glu__prompt_kernel_poll8x
    s_waitcnt vmcnt(0)
    v_cmp_gt_u32 vcc, 32, v31
    s_and_b64 vcc, vcc, exec
    s_cbranch_scc1 sequential_preLN__softmax_full_mha__glu_gated_glu__prompt_kernel_poll8
sequential_preLN__softmax_full_mha__glu_gated_glu__prompt_kernel_poll8x:
    s_mov_b64 exec, -1
sequential_preLN__softmax_full_mha__glu_gated_glu__prompt_kernel_b7b:
    s_barrier
    s_add_u32 m0, s18, 0
    s_add_u32 s16, s16, 4096
    buffer_load_dwordx4 v4, s[4:7], s16 offen offset:0 sc1 lds
    buffer_load_dwordx4 v4, s[4:7], s16 offen offset:1024 sc1 lds
    buffer_load_dwordx4 v4, s[4:7], s16 offen offset:2048 sc1 lds
    buffer_load_dwordx4 v4, s[4:7], s16 offen offset:3072 sc1 lds
    s_add_u32 m0, s18, 30720
    s_add_u32 s16, s16, 4096
    buffer_load_dwordx4 v4, s[4:7], s16 offen offset:0 sc1 lds
    buffer_load_dwordx4 v4, s[4:7], s16 offen offset:1024 sc1 lds
    buffer_load_dwordx4 v4, s[4:7], s16 offen offset:2048 sc1 lds
    buffer_load_dwordx4 v4, s[4:7], s16 offen offset:3072 sc1 lds
    s_lshl_b32 s45, s40, 2
    s_add_u32 s45, s45, s42
    s_lshl_b32 s45, s45, 13
    s_add_u32 s47, s45, 4096
    v_lshlrev_b32 v16, 3, v1
    v_cmp_le_u32 vcc, 112, v0
    v_mov_b32 v17, 13888
    s_mul_i32 s46, s41, 448
    v_cndmask_b32 v17, 0, v17, vcc
    v_lshl_add_u32 v17, v0, 2, v17
    buffer_load_dwordx2 a[144:145], v16, s[52:55], s45 offen offset:0 sc1
    buffer_load_dwordx2 a[146:147], v16, s[52:55], s45 offen offset:512 sc1
    buffer_load_dwordx2 a[148:149], v16, s[52:55], s45 offen offset:1024 sc1
    buffer_load_dwordx2 a[150:151], v16, s[52:55], s45 offen offset:1536 sc1
    buffer_load_dwordx2 a[152:153], v16, s[52:55], s45 offen offset:2048 sc1
    buffer_load_dwordx2 a[154:155], v16, s[52:55], s45 offen offset:2560 sc1
    buffer_load_dwordx2 a[156:157], v16, s[52:55], s45 offen offset:3072 sc1
    buffer_load_dwordx2 a[158:159], v16, s[52:55], s45 offen offset:3584 sc1
    buffer_load_dwordx2 a[160:161], v16, s[52:55], s47 offen offset:0 sc1
    buffer_load_dwordx2 a[162:163], v16, s[52:55], s47 offen offset:512 sc1
    buffer_load_dwordx2 a[164:165], v16, s[52:55], s47 offen offset:1024 sc1
    buffer_load_dwordx2 a[166:167], v16, s[52:55], s47 offen offset:1536 sc1
    buffer_load_dwordx2 a[168:169], v16, s[52:55], s47 offen offset:2048 sc1
    buffer_load_dwordx2 a[170:171], v16, s[52:55], s47 offen offset:2560 sc1
    buffer_load_dwordx2 a[172:173], v16, s[52:55], s47 offen offset:3072 sc1
    buffer_load_dwordx2 a[174:175], v16, s[52:55], s47 offen offset:3584 sc1
    buffer_load_dword a176, v17, s[56:59], s46 offen sc1
    s_add_u32 s46, s46, 28672
    buffer_load_dword a177, v17, s[56:59], s46 offen sc1
    s_add_u32 s46, s46, 28672
    buffer_load_dword a178, v17, s[56:59], s46 offen sc1
    s_add_u32 s46, s46, 28672
    buffer_load_dword a179, v17, s[56:59], s46 offen sc1
    s_add_u32 s46, s46, 28672
    buffer_load_dword a180, v17, s[56:59], s46 offen sc1
    s_add_u32 s46, s46, 28672
    buffer_load_dword a181, v17, s[56:59], s46 offen sc1
    s_add_u32 s46, s46, 28672
    buffer_load_dword a182, v17, s[56:59], s46 offen sc1
    s_add_u32 s46, s46, 28672
    buffer_load_dword a183, v17, s[56:59], s46 offen sc1
    s_add_u32 s46, s46, 28672
    s_add_u32 m0, s18, 61440
    s_add_u32 s16, s16, 4096
    buffer_load_dwordx4 v4, s[4:7], s16 offen offset:0 sc1 lds
    buffer_load_dwordx4 v4, s[4:7], s16 offen offset:1024 sc1 lds
    buffer_load_dwordx4 v4, s[4:7], s16 offen offset:2048 sc1 lds
    buffer_load_dwordx4 v4, s[4:7], s16 offen offset:3072 sc1 lds
    s_waitcnt vmcnt(28)
    s_barrier
    ds_read_b128 a[0:3], v12 offset:0
    ds_read_b128 a[4:7], v12 offset:1024
    ds_read_b128 a[8:11], v12 offset:2048
    ds_read_b128 a[12:15], v12 offset:3072
    ds_read_b64_tr_b16 a[32:33], v13 offset:0
    ds_read_b64_tr_b16 a[34:35], v13 offset:3584
    ds_read_b64_tr_b16 a[36:37], v13 offset:32
    ds_read_b64_tr_b16 a[38:39], v13 offset:3616
    ds_read_b64_tr_b16 a[40:41], v13 offset:64
    ds_read_b64_tr_b16 a[42:43], v13 offset:3648
    ds_read_b64_tr_b16 a[44:45], v13 offset:96
    ds_read_b64_tr_b16 a[46:47], v13 offset:3680
    ds_read_b64_tr_b16 a[48:49], v13 offset:128
    ds_read_b64_tr_b16 a[50:51], v13 offset:3712
    ds_read_b64_tr_b16 a[52:53], v13 offset:160
    ds_read_b64_tr_b16 a[54:55], v13 offset:3744
    ds_read_b64_tr_b16 a[56:57], v13 offset:192
    ds_read_b64_tr_b16 a[58:59], v13 offset:3776
    ds_read_b64_tr_b16 a[60:61], v13 offset:7168
    ds_read_b64_tr_b16 a[62:63], v13 offset:10752
    ds_read_b64_tr_b16 a[64:65], v13 offset:7200
    ds_read_b64_tr_b16 a[66:67], v13 offset:10784
    ds_read_b64_tr_b16 a[68:69], v13 offset:7232
    ds_read_b64_tr_b16 a[70:71], v13 offset:10816
    ds_read_b64_tr_b16 a[72:73], v13 offset:7264
    ds_read_b64_tr_b16 a[74:75], v13 offset:10848
    ds_read_b64_tr_b16 a[76:77], v13 offset:7296
    ds_read_b64_tr_b16 a[78:79], v13 offset:10880
    ds_read_b64_tr_b16 a[80:81], v13 offset:7328
    ds_read_b64_tr_b16 a[82:83], v13 offset:10912
    ds_read_b64_tr_b16 a[84:85], v13 offset:7360
    ds_read_b64_tr_b16 a[86:87], v13 offset:10944
    s_mov_b32 s20, 8
    s_waitcnt lgkmcnt(0)
sequential_preLN__softmax_full_mha__glu_gated_glu__prompt_kernel_p4loop:
    v_mfma_f32_16x16x32_bf16 v[32:35], a[32:35], a[0:3], v[32:35]
    s_waitcnt vmcnt(8)
    s_barrier
    v_mfma_f32_16x16x32_bf16 v[36:39], a[32:35], a[4:7], v[36:39]
    ds_read_b128 a[16:19], v12 offset:30720
    v_mfma_f32_16x16x32_bf16 v[40:43], a[32:35], a[8:11], v[40:43]
    s_add_u32 m0, s18, 92160
    v_mfma_f32_16x16x32_bf16 v[44:47], a[32:35], a[12:15], v[44:47]
    ds_read_b128 a[20:23], v12 offset:31744
    v_mfma_f32_16x16x32_bf16 v[48:51], a[36:39], a[0:3], v[48:51]
    ds_read_b128 a[24:27], v12 offset:32768
    v_mfma_f32_16x16x32_bf16 v[52:55], a[36:39], a[4:7], v[52:55]
    ds_read_b128 a[28:31], v12 offset:33792
    v_mfma_f32_16x16x32_bf16 v[56:59], a[36:39], a[8:11], v[56:59]
    s_add_u32 s16, s16, 4096
    v_mfma_f32_16x16x32_bf16 v[60:63], a[36:39], a[12:15], v[60:63]
    ds_read_b64_tr_b16 a[88:89], v13 offset:30720
    v_mfma_f32_16x16x32_bf16 v[64:67], a[40:43], a[0:3], v[64:67]
    ds_read_b64_tr_b16 a[90:91], v13 offset:34304
    v_mfma_f32_16x16x32_bf16 v[68:71], a[40:43], a[4:7], v[68:71]
    ds_read_b64_tr_b16 a[92:93], v13 offset:30752
    v_mfma_f32_16x16x32_bf16 v[72:75], a[40:43], a[8:11], v[72:75]
    buffer_load_dwordx4 v4, s[4:7], s16 offen offset:0 sc1 lds
    v_mfma_f32_16x16x32_bf16 v[76:79], a[40:43], a[12:15], v[76:79]
    ds_read_b64_tr_b16 a[94:95], v13 offset:34336
    v_mfma_f32_16x16x32_bf16 v[80:83], a[44:47], a[0:3], v[80:83]
    ds_read_b64_tr_b16 a[96:97], v13 offset:30784
    v_mfma_f32_16x16x32_bf16 v[84:87], a[44:47], a[4:7], v[84:87]
    buffer_load_dwordx4 v4, s[4:7], s16 offen offset:1024 sc1 lds
    v_mfma_f32_16x16x32_bf16 v[88:91], a[44:47], a[8:11], v[88:91]
    ds_read_b64_tr_b16 a[98:99], v13 offset:34368
    v_mfma_f32_16x16x32_bf16 v[92:95], a[44:47], a[12:15], v[92:95]
    ds_read_b64_tr_b16 a[100:101], v13 offset:30816
    v_mfma_f32_16x16x32_bf16 v[96:99], a[48:51], a[0:3], v[96:99]
    ds_read_b64_tr_b16 a[102:103], v13 offset:34400
    v_mfma_f32_16x16x32_bf16 v[100:103], a[48:51], a[4:7], v[100:103]
    buffer_load_dwordx4 v4, s[4:7], s16 offen offset:2048 sc1 lds
    v_mfma_f32_16x16x32_bf16 v[104:107], a[48:51], a[8:11], v[104:107]
    ds_read_b64_tr_b16 a[104:105], v13 offset:30848
    v_mfma_f32_16x16x32_bf16 v[108:111], a[48:51], a[12:15], v[108:111]
    ds_read_b64_tr_b16 a[106:107], v13 offset:34432
    v_mfma_f32_16x16x32_bf16 v[112:115], a[52:55], a[0:3], v[112:115]
    ds_read_b64_tr_b16 a[108:109], v13 offset:30880
    v_mfma_f32_16x16x32_bf16 v[116:119], a[52:55], a[4:7], v[116:119]
    buffer_load_dwordx4 v4, s[4:7], s16 offen offset:3072 sc1 lds
    v_mfma_f32_16x16x32_bf16 v[120:123], a[52:55], a[8:11], v[120:123]
    ds_read_b64_tr_b16 a[110:111], v13 offset:34464
    v_mfma_f32_16x16x32_bf16 v[124:127], a[52:55], a[12:15], v[124:127]
    v_mfma_f32_16x16x32_bf16 v[128:131], a[56:59], a[0:3], v[128:131]
    ds_read_b64_tr_b16 a[112:113], v13 offset:30912
    v_mfma_f32_16x16x32_bf16 v[132:135], a[56:59], a[4:7], v[132:135]
    s_add_u32 m0, s19, 92160
    v_mfma_f32_16x16x32_bf16 v[136:139], a[56:59], a[8:11], v[136:139]
    ds_read_b64_tr_b16 a[114:115], v13 offset:34496
    v_mfma_f32_16x16x32_bf16 v[140:143], a[56:59], a[12:15], v[140:143]
    ds_read_b64_tr_b16 a[116:117], v13 offset:37888
    v_mfma_f32_16x16x32_bf16 v[144:147], a[60:63], a[0:3], v[144:147]
    ds_read_b64_tr_b16 a[118:119], v13 offset:41472
    v_mfma_f32_16x16x32_bf16 v[148:151], a[60:63], a[4:7], v[148:151]
    s_add_u32 s17, s17, 229376
    v_mfma_f32_16x16x32_bf16 v[152:155], a[60:63], a[8:11], v[152:155]
    ds_read_b64_tr_b16 a[120:121], v13 offset:37920
    v_mfma_f32_16x16x32_bf16 v[156:159], a[60:63], a[12:15], v[156:159]
    ds_read_b64_tr_b16 a[122:123], v13 offset:41504
    v_mfma_f32_16x16x32_bf16 v[160:163], a[64:67], a[0:3], v[160:163]
    ds_read_b64_tr_b16 a[124:125], v13 offset:37952
    v_mfma_f32_16x16x32_bf16 v[164:167], a[64:67], a[4:7], v[164:167]
    buffer_load_dwordx4 v8, s[8:11], s17 offen offset:0 lds
    v_mfma_f32_16x16x32_bf16 v[168:171], a[64:67], a[8:11], v[168:171]
    ds_read_b64_tr_b16 a[126:127], v13 offset:41536
    v_mfma_f32_16x16x32_bf16 v[172:175], a[64:67], a[12:15], v[172:175]
    ds_read_b64_tr_b16 a[128:129], v13 offset:37984
    v_mfma_f32_16x16x32_bf16 v[176:179], a[68:71], a[0:3], v[176:179]
    buffer_load_dwordx4 v9, s[8:11], s17 offen offset:1024 lds
    v_mfma_f32_16x16x32_bf16 v[180:183], a[68:71], a[4:7], v[180:183]
    ds_read_b64_tr_b16 a[130:131], v13 offset:41568
    v_mfma_f32_16x16x32_bf16 v[184:187], a[68:71], a[8:11], v[184:187]
    ds_read_b64_tr_b16 a[132:133], v13 offset:38016
    v_mfma_f32_16x16x32_bf16 v[188:191], a[68:71], a[12:15], v[188:191]
    ds_read_b64_tr_b16 a[134:135], v13 offset:41600
    v_mfma_f32_16x16x32_bf16 v[192:195], a[72:75], a[0:3], v[192:195]
    buffer_load_dwordx4 v10, s[8:11], s17 offen offset:2048 lds
    v_mfma_f32_16x16x32_bf16 v[196:199], a[72:75], a[4:7], v[196:199]
    ds_read_b64_tr_b16 a[136:137], v13 offset:38048
    v_mfma_f32_16x16x32_bf16 v[200:203], a[72:75], a[8:11], v[200:203]
    ds_read_b64_tr_b16 a[138:139], v13 offset:41632
    v_mfma_f32_16x16x32_bf16 v[204:207], a[72:75], a[12:15], v[204:207]
    ds_read_b64_tr_b16 a[140:141], v13 offset:38080
    v_mfma_f32_16x16x32_bf16 v[208:211], a[76:79], a[0:3], v[208:211]
    buffer_load_dwordx4 v11, s[8:11], s17 offen offset:3072 lds
    v_mfma_f32_16x16x32_bf16 v[212:215], a[76:79], a[4:7], v[212:215]
    ds_read_b64_tr_b16 a[142:143], v13 offset:41664
    v_mfma_f32_16x16x32_bf16 v[216:219], a[76:79], a[8:11], v[216:219]
    v_mfma_f32_16x16x32_bf16 v[220:223], a[76:79], a[12:15], v[220:223]
    v_mfma_f32_16x16x32_bf16 v[224:227], a[80:83], a[0:3], v[224:227]
    v_mfma_f32_16x16x32_bf16 v[228:231], a[80:83], a[4:7], v[228:231]
    v_mfma_f32_16x16x32_bf16 v[232:235], a[80:83], a[8:11], v[232:235]
    v_mfma_f32_16x16x32_bf16 v[236:239], a[80:83], a[12:15], v[236:239]
    v_mfma_f32_16x16x32_bf16 v[240:243], a[84:87], a[0:3], v[240:243]
    v_mfma_f32_16x16x32_bf16 v[244:247], a[84:87], a[4:7], v[244:247]
    v_mfma_f32_16x16x32_bf16 v[248:251], a[84:87], a[8:11], v[248:251]
    v_mfma_f32_16x16x32_bf16 v[252:255], a[84:87], a[12:15], v[252:255]
    s_waitcnt lgkmcnt(0)
    v_mfma_f32_16x16x32_bf16 v[32:35], a[88:91], a[16:19], v[32:35]
    s_waitcnt vmcnt(8)
    s_barrier
    v_mfma_f32_16x16x32_bf16 v[36:39], a[88:91], a[20:23], v[36:39]
    ds_read_b128 a[0:3], v14 offset:0
    v_mfma_f32_16x16x32_bf16 v[40:43], a[88:91], a[24:27], v[40:43]
    s_add_u32 m0, s18, 0
    v_mfma_f32_16x16x32_bf16 v[44:47], a[88:91], a[28:31], v[44:47]
    ds_read_b128 a[4:7], v14 offset:1024
    v_mfma_f32_16x16x32_bf16 v[48:51], a[92:95], a[16:19], v[48:51]
    ds_read_b128 a[8:11], v14 offset:2048
    v_mfma_f32_16x16x32_bf16 v[52:55], a[92:95], a[20:23], v[52:55]
    ds_read_b128 a[12:15], v14 offset:3072
    v_mfma_f32_16x16x32_bf16 v[56:59], a[92:95], a[24:27], v[56:59]
    s_add_u32 s16, s16, 4096
    v_mfma_f32_16x16x32_bf16 v[60:63], a[92:95], a[28:31], v[60:63]
    ds_read_b64_tr_b16 a[32:33], v15 offset:0
    v_mfma_f32_16x16x32_bf16 v[64:67], a[96:99], a[16:19], v[64:67]
    ds_read_b64_tr_b16 a[34:35], v15 offset:3584
    v_mfma_f32_16x16x32_bf16 v[68:71], a[96:99], a[20:23], v[68:71]
    ds_read_b64_tr_b16 a[36:37], v15 offset:32
    v_mfma_f32_16x16x32_bf16 v[72:75], a[96:99], a[24:27], v[72:75]
    buffer_load_dwordx4 v4, s[4:7], s16 offen offset:0 sc1 lds
    v_mfma_f32_16x16x32_bf16 v[76:79], a[96:99], a[28:31], v[76:79]
    ds_read_b64_tr_b16 a[38:39], v15 offset:3616
    v_mfma_f32_16x16x32_bf16 v[80:83], a[100:103], a[16:19], v[80:83]
    ds_read_b64_tr_b16 a[40:41], v15 offset:64
    v_mfma_f32_16x16x32_bf16 v[84:87], a[100:103], a[20:23], v[84:87]
    buffer_load_dwordx4 v4, s[4:7], s16 offen offset:1024 sc1 lds
    v_mfma_f32_16x16x32_bf16 v[88:91], a[100:103], a[24:27], v[88:91]
    ds_read_b64_tr_b16 a[42:43], v15 offset:3648
    v_mfma_f32_16x16x32_bf16 v[92:95], a[100:103], a[28:31], v[92:95]
    ds_read_b64_tr_b16 a[44:45], v15 offset:96
    v_mfma_f32_16x16x32_bf16 v[96:99], a[104:107], a[16:19], v[96:99]
    ds_read_b64_tr_b16 a[46:47], v15 offset:3680
    v_mfma_f32_16x16x32_bf16 v[100:103], a[104:107], a[20:23], v[100:103]
    buffer_load_dwordx4 v4, s[4:7], s16 offen offset:2048 sc1 lds
    v_mfma_f32_16x16x32_bf16 v[104:107], a[104:107], a[24:27], v[104:107]
    ds_read_b64_tr_b16 a[48:49], v15 offset:128
    v_mfma_f32_16x16x32_bf16 v[108:111], a[104:107], a[28:31], v[108:111]
    ds_read_b64_tr_b16 a[50:51], v15 offset:3712
    v_mfma_f32_16x16x32_bf16 v[112:115], a[108:111], a[16:19], v[112:115]
    ds_read_b64_tr_b16 a[52:53], v15 offset:160
    v_mfma_f32_16x16x32_bf16 v[116:119], a[108:111], a[20:23], v[116:119]
    buffer_load_dwordx4 v4, s[4:7], s16 offen offset:3072 sc1 lds
    v_mfma_f32_16x16x32_bf16 v[120:123], a[108:111], a[24:27], v[120:123]
    ds_read_b64_tr_b16 a[54:55], v15 offset:3744
    v_mfma_f32_16x16x32_bf16 v[124:127], a[108:111], a[28:31], v[124:127]
    v_mfma_f32_16x16x32_bf16 v[128:131], a[112:115], a[16:19], v[128:131]
    ds_read_b64_tr_b16 a[56:57], v15 offset:192
    v_mfma_f32_16x16x32_bf16 v[132:135], a[112:115], a[20:23], v[132:135]
    s_add_u32 m0, s19, 0
    v_mfma_f32_16x16x32_bf16 v[136:139], a[112:115], a[24:27], v[136:139]
    ds_read_b64_tr_b16 a[58:59], v15 offset:3776
    v_mfma_f32_16x16x32_bf16 v[140:143], a[112:115], a[28:31], v[140:143]
    ds_read_b64_tr_b16 a[60:61], v15 offset:7168
    v_mfma_f32_16x16x32_bf16 v[144:147], a[116:119], a[16:19], v[144:147]
    ds_read_b64_tr_b16 a[62:63], v15 offset:10752
    v_mfma_f32_16x16x32_bf16 v[148:151], a[116:119], a[20:23], v[148:151]
    s_add_u32 s17, s17, 229376
    v_mfma_f32_16x16x32_bf16 v[152:155], a[116:119], a[24:27], v[152:155]
    ds_read_b64_tr_b16 a[64:65], v15 offset:7200
    v_mfma_f32_16x16x32_bf16 v[156:159], a[116:119], a[28:31], v[156:159]
    ds_read_b64_tr_b16 a[66:67], v15 offset:10784
    v_mfma_f32_16x16x32_bf16 v[160:163], a[120:123], a[16:19], v[160:163]
    ds_read_b64_tr_b16 a[68:69], v15 offset:7232
    v_mfma_f32_16x16x32_bf16 v[164:167], a[120:123], a[20:23], v[164:167]
    buffer_load_dwordx4 v8, s[8:11], s17 offen offset:0 lds
    v_mfma_f32_16x16x32_bf16 v[168:171], a[120:123], a[24:27], v[168:171]
    ds_read_b64_tr_b16 a[70:71], v15 offset:10816
    v_mfma_f32_16x16x32_bf16 v[172:175], a[120:123], a[28:31], v[172:175]
    ds_read_b64_tr_b16 a[72:73], v15 offset:7264
    v_mfma_f32_16x16x32_bf16 v[176:179], a[124:127], a[16:19], v[176:179]
    buffer_load_dwordx4 v9, s[8:11], s17 offen offset:1024 lds
    v_mfma_f32_16x16x32_bf16 v[180:183], a[124:127], a[20:23], v[180:183]
    ds_read_b64_tr_b16 a[74:75], v15 offset:10848
    v_mfma_f32_16x16x32_bf16 v[184:187], a[124:127], a[24:27], v[184:187]
    ds_read_b64_tr_b16 a[76:77], v15 offset:7296
    v_mfma_f32_16x16x32_bf16 v[188:191], a[124:127], a[28:31], v[188:191]
    ds_read_b64_tr_b16 a[78:79], v15 offset:10880
    v_mfma_f32_16x16x32_bf16 v[192:195], a[128:131], a[16:19], v[192:195]
    buffer_load_dwordx4 v10, s[8:11], s17 offen offset:2048 lds
    v_mfma_f32_16x16x32_bf16 v[196:199], a[128:131], a[20:23], v[196:199]
    ds_read_b64_tr_b16 a[80:81], v15 offset:7328
    v_mfma_f32_16x16x32_bf16 v[200:203], a[128:131], a[24:27], v[200:203]
    ds_read_b64_tr_b16 a[82:83], v15 offset:10912
    v_mfma_f32_16x16x32_bf16 v[204:207], a[128:131], a[28:31], v[204:207]
    ds_read_b64_tr_b16 a[84:85], v15 offset:7360
    v_mfma_f32_16x16x32_bf16 v[208:211], a[132:135], a[16:19], v[208:211]
    buffer_load_dwordx4 v11, s[8:11], s17 offen offset:3072 lds
    v_mfma_f32_16x16x32_bf16 v[212:215], a[132:135], a[20:23], v[212:215]
    ds_read_b64_tr_b16 a[86:87], v15 offset:10944
    v_mfma_f32_16x16x32_bf16 v[216:219], a[132:135], a[24:27], v[216:219]
    v_mfma_f32_16x16x32_bf16 v[220:223], a[132:135], a[28:31], v[220:223]
    v_mfma_f32_16x16x32_bf16 v[224:227], a[136:139], a[16:19], v[224:227]
    v_mfma_f32_16x16x32_bf16 v[228:231], a[136:139], a[20:23], v[228:231]
    v_mfma_f32_16x16x32_bf16 v[232:235], a[136:139], a[24:27], v[232:235]
    v_mfma_f32_16x16x32_bf16 v[236:239], a[136:139], a[28:31], v[236:239]
    v_mfma_f32_16x16x32_bf16 v[240:243], a[140:143], a[16:19], v[240:243]
    v_mfma_f32_16x16x32_bf16 v[244:247], a[140:143], a[20:23], v[244:247]
    v_mfma_f32_16x16x32_bf16 v[248:251], a[140:143], a[24:27], v[248:251]
    v_mfma_f32_16x16x32_bf16 v[252:255], a[140:143], a[28:31], v[252:255]
    s_waitcnt lgkmcnt(0)
    v_mfma_f32_16x16x32_bf16 v[32:35], a[32:35], a[0:3], v[32:35]
    s_waitcnt vmcnt(8)
    s_barrier
    v_mfma_f32_16x16x32_bf16 v[36:39], a[32:35], a[4:7], v[36:39]
    ds_read_b128 a[16:19], v14 offset:30720
    v_mfma_f32_16x16x32_bf16 v[40:43], a[32:35], a[8:11], v[40:43]
    s_add_u32 m0, s18, 30720
    v_mfma_f32_16x16x32_bf16 v[44:47], a[32:35], a[12:15], v[44:47]
    ds_read_b128 a[20:23], v14 offset:31744
    v_mfma_f32_16x16x32_bf16 v[48:51], a[36:39], a[0:3], v[48:51]
    ds_read_b128 a[24:27], v14 offset:32768
    v_mfma_f32_16x16x32_bf16 v[52:55], a[36:39], a[4:7], v[52:55]
    ds_read_b128 a[28:31], v14 offset:33792
    v_mfma_f32_16x16x32_bf16 v[56:59], a[36:39], a[8:11], v[56:59]
    s_add_u32 s16, s16, 4096
    v_mfma_f32_16x16x32_bf16 v[60:63], a[36:39], a[12:15], v[60:63]
    ds_read_b64_tr_b16 a[88:89], v15 offset:30720
    v_mfma_f32_16x16x32_bf16 v[64:67], a[40:43], a[0:3], v[64:67]
    ds_read_b64_tr_b16 a[90:91], v15 offset:34304
    v_mfma_f32_16x16x32_bf16 v[68:71], a[40:43], a[4:7], v[68:71]
    ds_read_b64_tr_b16 a[92:93], v15 offset:30752
    v_mfma_f32_16x16x32_bf16 v[72:75], a[40:43], a[8:11], v[72:75]
    buffer_load_dwordx4 v4, s[4:7], s16 offen offset:0 sc1 lds
    v_mfma_f32_16x16x32_bf16 v[76:79], a[40:43], a[12:15], v[76:79]
    ds_read_b64_tr_b16 a[94:95], v15 offset:34336
    v_mfma_f32_16x16x32_bf16 v[80:83], a[44:47], a[0:3], v[80:83]
    ds_read_b64_tr_b16 a[96:97], v15 offset:30784
    v_mfma_f32_16x16x32_bf16 v[84:87], a[44:47], a[4:7], v[84:87]
    buffer_load_dwordx4 v4, s[4:7], s16 offen offset:1024 sc1 lds
    v_mfma_f32_16x16x32_bf16 v[88:91], a[44:47], a[8:11], v[88:91]
    ds_read_b64_tr_b16 a[98:99], v15 offset:34368
    v_mfma_f32_16x16x32_bf16 v[92:95], a[44:47], a[12:15], v[92:95]
    ds_read_b64_tr_b16 a[100:101], v15 offset:30816
    v_mfma_f32_16x16x32_bf16 v[96:99], a[48:51], a[0:3], v[96:99]
    ds_read_b64_tr_b16 a[102:103], v15 offset:34400
    v_mfma_f32_16x16x32_bf16 v[100:103], a[48:51], a[4:7], v[100:103]
    buffer_load_dwordx4 v4, s[4:7], s16 offen offset:2048 sc1 lds
    v_mfma_f32_16x16x32_bf16 v[104:107], a[48:51], a[8:11], v[104:107]
    ds_read_b64_tr_b16 a[104:105], v15 offset:30848
    v_mfma_f32_16x16x32_bf16 v[108:111], a[48:51], a[12:15], v[108:111]
    ds_read_b64_tr_b16 a[106:107], v15 offset:34432
    v_mfma_f32_16x16x32_bf16 v[112:115], a[52:55], a[0:3], v[112:115]
    ds_read_b64_tr_b16 a[108:109], v15 offset:30880
    v_mfma_f32_16x16x32_bf16 v[116:119], a[52:55], a[4:7], v[116:119]
    buffer_load_dwordx4 v4, s[4:7], s16 offen offset:3072 sc1 lds
    v_mfma_f32_16x16x32_bf16 v[120:123], a[52:55], a[8:11], v[120:123]
    ds_read_b64_tr_b16 a[110:111], v15 offset:34464
    v_mfma_f32_16x16x32_bf16 v[124:127], a[52:55], a[12:15], v[124:127]
    v_mfma_f32_16x16x32_bf16 v[128:131], a[56:59], a[0:3], v[128:131]
    ds_read_b64_tr_b16 a[112:113], v15 offset:30912
    v_mfma_f32_16x16x32_bf16 v[132:135], a[56:59], a[4:7], v[132:135]
    s_add_u32 m0, s19, 30720
    v_mfma_f32_16x16x32_bf16 v[136:139], a[56:59], a[8:11], v[136:139]
    ds_read_b64_tr_b16 a[114:115], v15 offset:34496
    v_mfma_f32_16x16x32_bf16 v[140:143], a[56:59], a[12:15], v[140:143]
    ds_read_b64_tr_b16 a[116:117], v15 offset:37888
    v_mfma_f32_16x16x32_bf16 v[144:147], a[60:63], a[0:3], v[144:147]
    ds_read_b64_tr_b16 a[118:119], v15 offset:41472
    v_mfma_f32_16x16x32_bf16 v[148:151], a[60:63], a[4:7], v[148:151]
    s_add_u32 s17, s17, 229376
    v_mfma_f32_16x16x32_bf16 v[152:155], a[60:63], a[8:11], v[152:155]
    ds_read_b64_tr_b16 a[120:121], v15 offset:37920
    v_mfma_f32_16x16x32_bf16 v[156:159], a[60:63], a[12:15], v[156:159]
    ds_read_b64_tr_b16 a[122:123], v15 offset:41504
    v_mfma_f32_16x16x32_bf16 v[160:163], a[64:67], a[0:3], v[160:163]
    ds_read_b64_tr_b16 a[124:125], v15 offset:37952
    v_mfma_f32_16x16x32_bf16 v[164:167], a[64:67], a[4:7], v[164:167]
    buffer_load_dwordx4 v8, s[8:11], s17 offen offset:0 lds
    v_mfma_f32_16x16x32_bf16 v[168:171], a[64:67], a[8:11], v[168:171]
    ds_read_b64_tr_b16 a[126:127], v15 offset:41536
    v_mfma_f32_16x16x32_bf16 v[172:175], a[64:67], a[12:15], v[172:175]
    ds_read_b64_tr_b16 a[128:129], v15 offset:37984
    v_mfma_f32_16x16x32_bf16 v[176:179], a[68:71], a[0:3], v[176:179]
    buffer_load_dwordx4 v9, s[8:11], s17 offen offset:1024 lds
    v_mfma_f32_16x16x32_bf16 v[180:183], a[68:71], a[4:7], v[180:183]
    ds_read_b64_tr_b16 a[130:131], v15 offset:41568
    v_mfma_f32_16x16x32_bf16 v[184:187], a[68:71], a[8:11], v[184:187]
    ds_read_b64_tr_b16 a[132:133], v15 offset:38016
    v_mfma_f32_16x16x32_bf16 v[188:191], a[68:71], a[12:15], v[188:191]
    ds_read_b64_tr_b16 a[134:135], v15 offset:41600
    v_mfma_f32_16x16x32_bf16 v[192:195], a[72:75], a[0:3], v[192:195]
    buffer_load_dwordx4 v10, s[8:11], s17 offen offset:2048 lds
    v_mfma_f32_16x16x32_bf16 v[196:199], a[72:75], a[4:7], v[196:199]
    ds_read_b64_tr_b16 a[136:137], v15 offset:38048
    v_mfma_f32_16x16x32_bf16 v[200:203], a[72:75], a[8:11], v[200:203]
    ds_read_b64_tr_b16 a[138:139], v15 offset:41632
    v_mfma_f32_16x16x32_bf16 v[204:207], a[72:75], a[12:15], v[204:207]
    ds_read_b64_tr_b16 a[140:141], v15 offset:38080
    v_mfma_f32_16x16x32_bf16 v[208:211], a[76:79], a[0:3], v[208:211]
    buffer_load_dwordx4 v11, s[8:11], s17 offen offset:3072 lds
    v_mfma_f32_16x16x32_bf16 v[212:215], a[76:79], a[4:7], v[212:215]
    ds_read_b64_tr_b16 a[142:143], v15 offset:41664
    v_mfma_f32_16x16x32_bf16 v[216:219], a[76:79], a[8:11], v[216:219]
    v_mfma_f32_16x16x32_bf16 v[220:223], a[76:79], a[12:15], v[220:223]
    v_mfma_f32_16x16x32_bf16 v[224:227], a[80:83], a[0:3], v[224:227]
    v_mfma_f32_16x16x32_bf16 v[228:231], a[80:83], a[4:7], v[228:231]
    v_mfma_f32_16x16x32_bf16 v[232:235], a[80:83], a[8:11], v[232:235]
    v_mfma_f32_16x16x32_bf16 v[236:239], a[80:83], a[12:15], v[236:239]
    v_mfma_f32_16x16x32_bf16 v[240:243], a[84:87], a[0:3], v[240:243]
    v_mfma_f32_16x16x32_bf16 v[244:247], a[84:87], a[4:7], v[244:247]
    v_mfma_f32_16x16x32_bf16 v[248:251], a[84:87], a[8:11], v[248:251]
    v_mfma_f32_16x16x32_bf16 v[252:255], a[84:87], a[12:15], v[252:255]
    s_waitcnt lgkmcnt(0)
    v_mfma_f32_16x16x32_bf16 v[32:35], a[88:91], a[16:19], v[32:35]
    s_waitcnt vmcnt(8)
    s_barrier
    v_mfma_f32_16x16x32_bf16 v[36:39], a[88:91], a[20:23], v[36:39]
    ds_read_b128 a[0:3], v12 offset:0
    v_mfma_f32_16x16x32_bf16 v[40:43], a[88:91], a[24:27], v[40:43]
    s_add_u32 m0, s18, 61440
    v_mfma_f32_16x16x32_bf16 v[44:47], a[88:91], a[28:31], v[44:47]
    ds_read_b128 a[4:7], v12 offset:1024
    v_mfma_f32_16x16x32_bf16 v[48:51], a[92:95], a[16:19], v[48:51]
    ds_read_b128 a[8:11], v12 offset:2048
    v_mfma_f32_16x16x32_bf16 v[52:55], a[92:95], a[20:23], v[52:55]
    ds_read_b128 a[12:15], v12 offset:3072
    v_mfma_f32_16x16x32_bf16 v[56:59], a[92:95], a[24:27], v[56:59]
    s_add_u32 s16, s16, 4096
    v_mfma_f32_16x16x32_bf16 v[60:63], a[92:95], a[28:31], v[60:63]
    ds_read_b64_tr_b16 a[32:33], v13 offset:0
    v_mfma_f32_16x16x32_bf16 v[64:67], a[96:99], a[16:19], v[64:67]
    ds_read_b64_tr_b16 a[34:35], v13 offset:3584
    v_mfma_f32_16x16x32_bf16 v[68:71], a[96:99], a[20:23], v[68:71]
    ds_read_b64_tr_b16 a[36:37], v13 offset:32
    v_mfma_f32_16x16x32_bf16 v[72:75], a[96:99], a[24:27], v[72:75]
    buffer_load_dwordx4 v4, s[4:7], s16 offen offset:0 sc1 lds
    v_mfma_f32_16x16x32_bf16 v[76:79], a[96:99], a[28:31], v[76:79]
    ds_read_b64_tr_b16 a[38:39], v13 offset:3616
    v_mfma_f32_16x16x32_bf16 v[80:83], a[100:103], a[16:19], v[80:83]
    ds_read_b64_tr_b16 a[40:41], v13 offset:64
    v_mfma_f32_16x16x32_bf16 v[84:87], a[100:103], a[20:23], v[84:87]
    buffer_load_dwordx4 v4, s[4:7], s16 offen offset:1024 sc1 lds
    v_mfma_f32_16x16x32_bf16 v[88:91], a[100:103], a[24:27], v[88:91]
    ds_read_b64_tr_b16 a[42:43], v13 offset:3648
    v_mfma_f32_16x16x32_bf16 v[92:95], a[100:103], a[28:31], v[92:95]
    ds_read_b64_tr_b16 a[44:45], v13 offset:96
    v_mfma_f32_16x16x32_bf16 v[96:99], a[104:107], a[16:19], v[96:99]
    ds_read_b64_tr_b16 a[46:47], v13 offset:3680
    v_mfma_f32_16x16x32_bf16 v[100:103], a[104:107], a[20:23], v[100:103]
    buffer_load_dwordx4 v4, s[4:7], s16 offen offset:2048 sc1 lds
    v_mfma_f32_16x16x32_bf16 v[104:107], a[104:107], a[24:27], v[104:107]
    ds_read_b64_tr_b16 a[48:49], v13 offset:128
    v_mfma_f32_16x16x32_bf16 v[108:111], a[104:107], a[28:31], v[108:111]
    ds_read_b64_tr_b16 a[50:51], v13 offset:3712
    v_mfma_f32_16x16x32_bf16 v[112:115], a[108:111], a[16:19], v[112:115]
    ds_read_b64_tr_b16 a[52:53], v13 offset:160
    v_mfma_f32_16x16x32_bf16 v[116:119], a[108:111], a[20:23], v[116:119]
    buffer_load_dwordx4 v4, s[4:7], s16 offen offset:3072 sc1 lds
    v_mfma_f32_16x16x32_bf16 v[120:123], a[108:111], a[24:27], v[120:123]
    ds_read_b64_tr_b16 a[54:55], v13 offset:3744
    v_mfma_f32_16x16x32_bf16 v[124:127], a[108:111], a[28:31], v[124:127]
    v_mfma_f32_16x16x32_bf16 v[128:131], a[112:115], a[16:19], v[128:131]
    ds_read_b64_tr_b16 a[56:57], v13 offset:192
    v_mfma_f32_16x16x32_bf16 v[132:135], a[112:115], a[20:23], v[132:135]
    s_add_u32 m0, s19, 61440
    v_mfma_f32_16x16x32_bf16 v[136:139], a[112:115], a[24:27], v[136:139]
    ds_read_b64_tr_b16 a[58:59], v13 offset:3776
    v_mfma_f32_16x16x32_bf16 v[140:143], a[112:115], a[28:31], v[140:143]
    ds_read_b64_tr_b16 a[60:61], v13 offset:7168
    v_mfma_f32_16x16x32_bf16 v[144:147], a[116:119], a[16:19], v[144:147]
    ds_read_b64_tr_b16 a[62:63], v13 offset:10752
    v_mfma_f32_16x16x32_bf16 v[148:151], a[116:119], a[20:23], v[148:151]
    s_add_u32 s17, s17, 229376
    v_mfma_f32_16x16x32_bf16 v[152:155], a[116:119], a[24:27], v[152:155]
    ds_read_b64_tr_b16 a[64:65], v13 offset:7200
    v_mfma_f32_16x16x32_bf16 v[156:159], a[116:119], a[28:31], v[156:159]
    ds_read_b64_tr_b16 a[66:67], v13 offset:10784
    v_mfma_f32_16x16x32_bf16 v[160:163], a[120:123], a[16:19], v[160:163]
    ds_read_b64_tr_b16 a[68:69], v13 offset:7232
    v_mfma_f32_16x16x32_bf16 v[164:167], a[120:123], a[20:23], v[164:167]
    buffer_load_dwordx4 v8, s[8:11], s17 offen offset:0 lds
    v_mfma_f32_16x16x32_bf16 v[168:171], a[120:123], a[24:27], v[168:171]
    ds_read_b64_tr_b16 a[70:71], v13 offset:10816
    v_mfma_f32_16x16x32_bf16 v[172:175], a[120:123], a[28:31], v[172:175]
    ds_read_b64_tr_b16 a[72:73], v13 offset:7264
    v_mfma_f32_16x16x32_bf16 v[176:179], a[124:127], a[16:19], v[176:179]
    buffer_load_dwordx4 v9, s[8:11], s17 offen offset:1024 lds
    v_mfma_f32_16x16x32_bf16 v[180:183], a[124:127], a[20:23], v[180:183]
    ds_read_b64_tr_b16 a[74:75], v13 offset:10848
    v_mfma_f32_16x16x32_bf16 v[184:187], a[124:127], a[24:27], v[184:187]
    ds_read_b64_tr_b16 a[76:77], v13 offset:7296
    v_mfma_f32_16x16x32_bf16 v[188:191], a[124:127], a[28:31], v[188:191]
    ds_read_b64_tr_b16 a[78:79], v13 offset:10880
    v_mfma_f32_16x16x32_bf16 v[192:195], a[128:131], a[16:19], v[192:195]
    buffer_load_dwordx4 v10, s[8:11], s17 offen offset:2048 lds
    v_mfma_f32_16x16x32_bf16 v[196:199], a[128:131], a[20:23], v[196:199]
    ds_read_b64_tr_b16 a[80:81], v13 offset:7328
    v_mfma_f32_16x16x32_bf16 v[200:203], a[128:131], a[24:27], v[200:203]
    ds_read_b64_tr_b16 a[82:83], v13 offset:10912
    v_mfma_f32_16x16x32_bf16 v[204:207], a[128:131], a[28:31], v[204:207]
    ds_read_b64_tr_b16 a[84:85], v13 offset:7360
    v_mfma_f32_16x16x32_bf16 v[208:211], a[132:135], a[16:19], v[208:211]
    buffer_load_dwordx4 v11, s[8:11], s17 offen offset:3072 lds
    v_mfma_f32_16x16x32_bf16 v[212:215], a[132:135], a[20:23], v[212:215]
    ds_read_b64_tr_b16 a[86:87], v13 offset:10944
    v_mfma_f32_16x16x32_bf16 v[216:219], a[132:135], a[24:27], v[216:219]
    v_mfma_f32_16x16x32_bf16 v[220:223], a[132:135], a[28:31], v[220:223]
    v_mfma_f32_16x16x32_bf16 v[224:227], a[136:139], a[16:19], v[224:227]
    v_mfma_f32_16x16x32_bf16 v[228:231], a[136:139], a[20:23], v[228:231]
    v_mfma_f32_16x16x32_bf16 v[232:235], a[136:139], a[24:27], v[232:235]
    v_mfma_f32_16x16x32_bf16 v[236:239], a[136:139], a[28:31], v[236:239]
    v_mfma_f32_16x16x32_bf16 v[240:243], a[140:143], a[16:19], v[240:243]
    v_mfma_f32_16x16x32_bf16 v[244:247], a[140:143], a[20:23], v[244:247]
    s_sub_u32 s20, s20, 1
    v_mfma_f32_16x16x32_bf16 v[248:251], a[140:143], a[24:27], v[248:251]
    s_cmp_lg_u32 s20, 0
    v_mfma_f32_16x16x32_bf16 v[252:255], a[140:143], a[28:31], v[252:255]
    s_waitcnt lgkmcnt(0)
    s_cbranch_scc1 sequential_preLN__softmax_full_mha__glu_gated_glu__prompt_kernel_p4loop
    s_waitcnt vmcnt(0)
    s_barrier
    s_nop 5
    v_accvgpr_read_b32 v5, a176
    v_accvgpr_read_b32 v6, a177
    v_add_f32 v5, v5, v6
    v_accvgpr_read_b32 v6, a178
    v_add_f32 v5, v5, v6
    v_accvgpr_read_b32 v6, a179
    v_add_f32 v5, v5, v6
    v_accvgpr_read_b32 v6, a180
    v_add_f32 v5, v5, v6
    v_accvgpr_read_b32 v6, a181
    v_add_f32 v5, v5, v6
    v_accvgpr_read_b32 v6, a182
    v_add_f32 v5, v5, v6
    v_accvgpr_read_b32 v6, a183
    v_add_f32 v5, v5, v6
    v_lshlrev_b32 v6, 2, v0
    v_add_u32 v6, 122880, v6
    ds_write_b32 v6, v5
    v_accvgpr_read_b32 v18, a144
    v_accvgpr_read_b32 v19, a145
    v_accvgpr_read_b32 v6, a146
    v_accvgpr_read_b32 v7, a147
    v_pk_add_f32 v[18:19], v[18:19], v[6:7] op_sel:[0,0] op_sel_hi:[1,1]
    v_accvgpr_read_b32 v6, a148
    v_accvgpr_read_b32 v7, a149
    v_pk_add_f32 v[18:19], v[18:19], v[6:7] op_sel:[0,0] op_sel_hi:[1,1]
    v_accvgpr_read_b32 v6, a150
    v_accvgpr_read_b32 v7, a151
    v_pk_add_f32 v[18:19], v[18:19], v[6:7] op_sel:[0,0] op_sel_hi:[1,1]
    v_accvgpr_read_b32 v6, a152
    v_accvgpr_read_b32 v7, a153
    v_pk_add_f32 v[18:19], v[18:19], v[6:7] op_sel:[0,0] op_sel_hi:[1,1]
    v_accvgpr_read_b32 v6, a154
    v_accvgpr_read_b32 v7, a155
    v_pk_add_f32 v[18:19], v[18:19], v[6:7] op_sel:[0,0] op_sel_hi:[1,1]
    v_accvgpr_read_b32 v6, a156
    v_accvgpr_read_b32 v7, a157
    v_pk_add_f32 v[18:19], v[18:19], v[6:7] op_sel:[0,0] op_sel_hi:[1,1]
    v_accvgpr_read_b32 v6, a158
    v_accvgpr_read_b32 v7, a159
    v_pk_add_f32 v[18:19], v[18:19], v[6:7] op_sel:[0,0] op_sel_hi:[1,1]
    v_accvgpr_read_b32 v6, a160
    v_accvgpr_read_b32 v7, a161
    v_pk_add_f32 v[18:19], v[18:19], v[6:7] op_sel:[0,0] op_sel_hi:[1,1]
    v_accvgpr_read_b32 v6, a162
    v_accvgpr_read_b32 v7, a163
    v_pk_add_f32 v[18:19], v[18:19], v[6:7] op_sel:[0,0] op_sel_hi:[1,1]
    v_accvgpr_read_b32 v6, a164
    v_accvgpr_read_b32 v7, a165
    v_pk_add_f32 v[18:19], v[18:19], v[6:7] op_sel:[0,0] op_sel_hi:[1,1]
    v_accvgpr_read_b32 v6, a166
    v_accvgpr_read_b32 v7, a167
    v_pk_add_f32 v[18:19], v[18:19], v[6:7] op_sel:[0,0] op_sel_hi:[1,1]
    v_accvgpr_read_b32 v6, a168
    v_accvgpr_read_b32 v7, a169
    v_pk_add_f32 v[18:19], v[18:19], v[6:7] op_sel:[0,0] op_sel_hi:[1,1]
    v_accvgpr_read_b32 v6, a170
    v_accvgpr_read_b32 v7, a171
    v_pk_add_f32 v[18:19], v[18:19], v[6:7] op_sel:[0,0] op_sel_hi:[1,1]
    v_accvgpr_read_b32 v6, a172
    v_accvgpr_read_b32 v7, a173
    v_pk_add_f32 v[18:19], v[18:19], v[6:7] op_sel:[0,0] op_sel_hi:[1,1]
    v_accvgpr_read_b32 v6, a174
    v_accvgpr_read_b32 v7, a175
    v_pk_add_f32 v[18:19], v[18:19], v[6:7] op_sel:[0,0] op_sel_hi:[1,1]
    v_mul_f32 v18, 0xba800000, v18
    v_mul_f32 v19, 0x3a800000, v19
    v_fma_f32 v19, -v18, v18, v19
    v_max_f32 v19, 0, v19
    v_add_f32 v19, 0x3727c5ac, v19
    v_sqrt_f32 v19, v19
    v_lshlrev_b32 v5, 2, v3
    v_lshlrev_b32 v30, 4, v2
    v_add_u32 v30, 122880, v30
    v_and_b32 v29, 31, v1
    v_lshlrev_b32 v29, 4, v29
    v_and_b32 v28, 32, v1
    v_lshl_add_u32 v29, v28, 5, v29
    ds_bpermute_b32 v8, v5, v18 offset:0
    ds_bpermute_b32 v12, v5, v19 offset:0
    ds_bpermute_b32 v9, v5, v18 offset:64
    ds_bpermute_b32 v13, v5, v19 offset:64
    ds_bpermute_b32 v10, v5, v18 offset:128
    ds_bpermute_b32 v14, v5, v19 offset:128
    ds_bpermute_b32 v11, v5, v18 offset:192
    ds_bpermute_b32 v15, v5, v19 offset:192
    s_lshl_b32 s45, s40, 2
    s_add_u32 s45, s45, s42
    s_mul_i32 s45, s45, 458752
    s_mul_i32 s46, s41, 7
    s_waitcnt lgkmcnt(0)
    s_barrier
    ds_read_b128 v[20:23], v30
    ds_read_b128 v[24:27], v30 offset:448
    v_rcp_f32 v16, v12
    v_rcp_f32 v17, v13
    v_rcp_f32 v18, v14
    v_rcp_f32 v19, v15
    s_nop 0
    v_mul_f32 v16, 0xbfb8aa3b, v16
    v_mul_f32 v17, 0xbfb8aa3b, v17
    v_mul_f32 v18, 0xbfb8aa3b, v18
    v_mul_f32 v19, 0xbfb8aa3b, v19
    s_add_u32 s47, s46, 0
    s_lshr_b32 s48, s47, 1
    s_lshl_b32 s48, s48, 12
    s_and_b32 s47, s47, 1
    s_lshl_b32 s47, s47, 9
    s_add_u32 s48, s48, s47
    s_add_u32 s48, s48, s45
    s_waitcnt lgkmcnt(0)
    v_pk_fma_f32 v[32:33], v[20:21], v[8:9], v[32:33] op_sel:[0,0,0] op_sel_hi:[1,0,1]
    v_pk_fma_f32 v[144:145], v[24:25], v[8:9], v[144:145] op_sel:[0,0,0] op_sel_hi:[1,0,1]
    v_pk_fma_f32 v[34:35], v[22:23], v[8:9], v[34:35] op_sel:[0,0,0] op_sel_hi:[1,0,1]
    v_pk_fma_f32 v[146:147], v[26:27], v[8:9], v[146:147] op_sel:[0,0,0] op_sel_hi:[1,0,1]
    v_pk_fma_f32 v[36:37], v[20:21], v[8:9], v[36:37] op_sel:[0,1,0] op_sel_hi:[1,1,1]
    v_pk_fma_f32 v[148:149], v[24:25], v[8:9], v[148:149] op_sel:[0,1,0] op_sel_hi:[1,1,1]
    v_pk_fma_f32 v[38:39], v[22:23], v[8:9], v[38:39] op_sel:[0,1,0] op_sel_hi:[1,1,1]
    v_pk_fma_f32 v[150:151], v[26:27], v[8:9], v[150:151] op_sel:[0,1,0] op_sel_hi:[1,1,1]
    v_pk_fma_f32 v[40:41], v[20:21], v[10:11], v[40:41] op_sel:[0,0,0] op_sel_hi:[1,0,1]
    v_pk_fma_f32 v[152:153], v[24:25], v[10:11], v[152:153] op_sel:[0,0,0] op_sel_hi:[1,0,1]
    v_pk_fma_f32 v[42:43], v[22:23], v[10:11], v[42:43] op_sel:[0,0,0] op_sel_hi:[1,0,1]
    v_pk_fma_f32 v[154:155], v[26:27], v[10:11], v[154:155] op_sel:[0,0,0] op_sel_hi:[1,0,1]
    v_pk_fma_f32 v[44:45], v[20:21], v[10:11], v[44:45] op_sel:[0,1,0] op_sel_hi:[1,1,1]
    v_pk_fma_f32 v[156:157], v[24:25], v[10:11], v[156:157] op_sel:[0,1,0] op_sel_hi:[1,1,1]
    v_pk_fma_f32 v[46:47], v[22:23], v[10:11], v[46:47] op_sel:[0,1,0] op_sel_hi:[1,1,1]
    v_pk_fma_f32 v[158:159], v[26:27], v[10:11], v[158:159] op_sel:[0,1,0] op_sel_hi:[1,1,1]
    ds_read_b128 v[20:23], v30 offset:64
    ds_read_b128 v[24:27], v30 offset:512
    v_pk_mul_f32 v[32:33], v[32:33], v[16:17] op_sel:[0,0] op_sel_hi:[1,0]
    v_pk_mul_f32 v[34:35], v[34:35], v[16:17] op_sel:[0,0] op_sel_hi:[1,0]
    v_pk_mul_f32 v[36:37], v[36:37], v[16:17] op_sel:[0,1] op_sel_hi:[1,1]
    v_pk_mul_f32 v[38:39], v[38:39], v[16:17] op_sel:[0,1] op_sel_hi:[1,1]
    v_pk_mul_f32 v[40:41], v[40:41], v[18:19] op_sel:[0,0] op_sel_hi:[1,0]
    v_pk_mul_f32 v[42:43], v[42:43], v[18:19] op_sel:[0,0] op_sel_hi:[1,0]
    v_pk_mul_f32 v[44:45], v[44:45], v[18:19] op_sel:[0,1] op_sel_hi:[1,1]
    v_pk_mul_f32 v[46:47], v[46:47], v[18:19] op_sel:[0,1] op_sel_hi:[1,1]
    v_exp_f32 v32, v32
    v_exp_f32 v33, v33
    v_exp_f32 v34, v34
    v_exp_f32 v35, v35
    v_exp_f32 v36, v36
    v_exp_f32 v37, v37
    v_exp_f32 v38, v38
    v_exp_f32 v39, v39
    v_exp_f32 v40, v40
    v_exp_f32 v41, v41
    v_exp_f32 v42, v42
    v_exp_f32 v43, v43
    v_exp_f32 v44, v44
    v_exp_f32 v45, v45
    v_exp_f32 v46, v46
    v_exp_f32 v47, v47
    v_pk_fma_f32 v[32:33], v[32:33], v[12:13], v[12:13] op_sel:[0,0,0] op_sel_hi:[1,0,0]
    v_pk_fma_f32 v[34:35], v[34:35], v[12:13], v[12:13] op_sel:[0,0,0] op_sel_hi:[1,0,0]
    v_pk_fma_f32 v[36:37], v[36:37], v[12:13], v[12:13] op_sel:[0,1,1] op_sel_hi:[1,1,1]
    v_pk_fma_f32 v[38:39], v[38:39], v[12:13], v[12:13] op_sel:[0,1,1] op_sel_hi:[1,1,1]
    v_pk_fma_f32 v[40:41], v[40:41], v[14:15], v[14:15] op_sel:[0,0,0] op_sel_hi:[1,0,0]
    v_pk_fma_f32 v[42:43], v[42:43], v[14:15], v[14:15] op_sel:[0,0,0] op_sel_hi:[1,0,0]
    v_pk_fma_f32 v[44:45], v[44:45], v[14:15], v[14:15] op_sel:[0,1,1] op_sel_hi:[1,1,1]
    v_pk_fma_f32 v[46:47], v[46:47], v[14:15], v[14:15] op_sel:[0,1,1] op_sel_hi:[1,1,1]
    v_rcp_f32 v32, v32
    v_rcp_f32 v33, v33
    v_rcp_f32 v34, v34
    v_rcp_f32 v35, v35
    v_rcp_f32 v36, v36
    v_rcp_f32 v37, v37
    v_rcp_f32 v38, v38
    v_rcp_f32 v39, v39
    v_rcp_f32 v40, v40
    v_rcp_f32 v41, v41
    v_rcp_f32 v42, v42
    v_rcp_f32 v43, v43
    v_rcp_f32 v44, v44
    v_rcp_f32 v45, v45
    v_rcp_f32 v46, v46
    v_rcp_f32 v47, v47
    v_pk_mul_f32 v[32:33], v[32:33], v[144:145] op_sel:[0,0] op_sel_hi:[1,1]
    v_pk_mul_f32 v[34:35], v[34:35], v[146:147] op_sel:[0,0] op_sel_hi:[1,1]
    v_pk_mul_f32 v[36:37], v[36:37], v[148:149] op_sel:[0,0] op_sel_hi:[1,1]
    v_pk_mul_f32 v[38:39], v[38:39], v[150:151] op_sel:[0,0] op_sel_hi:[1,1]
    v_pk_mul_f32 v[40:41], v[40:41], v[152:153] op_sel:[0,0] op_sel_hi:[1,1]
    v_pk_mul_f32 v[42:43], v[42:43], v[154:155] op_sel:[0,0] op_sel_hi:[1,1]
    v_pk_mul_f32 v[44:45], v[44:45], v[156:157] op_sel:[0,0] op_sel_hi:[1,1]
    v_pk_mul_f32 v[46:47], v[46:47], v[158:159] op_sel:[0,0] op_sel_hi:[1,1]
    v_cvt_pk_bf16_f32 v32, v32, v33
    v_cvt_pk_bf16_f32 v33, v34, v35
    v_cvt_pk_bf16_f32 v34, v36, v37
    v_cvt_pk_bf16_f32 v35, v38, v39
    v_cvt_pk_bf16_f32 v40, v40, v41
    v_cvt_pk_bf16_f32 v41, v42, v43
    v_cvt_pk_bf16_f32 v42, v44, v45
    v_cvt_pk_bf16_f32 v43, v46, v47
    v_permlane32_swap_b32 v32, v34
    v_permlane32_swap_b32 v33, v35
    buffer_store_dwordx4 v[32:35], v29, s[12:15], s48 offen offset:0 sc1
    s_nop 0
    v_permlane32_swap_b32 v40, v42
    v_permlane32_swap_b32 v41, v43
    buffer_store_dwordx4 v[40:43], v29, s[12:15], s48 offen offset:2048 sc1
    s_add_u32 s47, s46, 1
    s_lshr_b32 s48, s47, 1
    s_lshl_b32 s48, s48, 12
    s_and_b32 s47, s47, 1
    s_lshl_b32 s47, s47, 9
    s_add_u32 s48, s48, s47
    s_add_u32 s48, s48, s45
    s_waitcnt lgkmcnt(0)
    v_pk_fma_f32 v[48:49], v[20:21], v[8:9], v[48:49] op_sel:[0,0,0] op_sel_hi:[1,0,1]
    v_pk_fma_f32 v[160:161], v[24:25], v[8:9], v[160:161] op_sel:[0,0,0] op_sel_hi:[1,0,1]
    v_pk_fma_f32 v[50:51], v[22:23], v[8:9], v[50:51] op_sel:[0,0,0] op_sel_hi:[1,0,1]
    v_pk_fma_f32 v[162:163], v[26:27], v[8:9], v[162:163] op_sel:[0,0,0] op_sel_hi:[1,0,1]
    v_pk_fma_f32 v[52:53], v[20:21], v[8:9], v[52:53] op_sel:[0,1,0] op_sel_hi:[1,1,1]
    v_pk_fma_f32 v[164:165], v[24:25], v[8:9], v[164:165] op_sel:[0,1,0] op_sel_hi:[1,1,1]
    v_pk_fma_f32 v[54:55], v[22:23], v[8:9], v[54:55] op_sel:[0,1,0] op_sel_hi:[1,1,1]
    v_pk_fma_f32 v[166:167], v[26:27], v[8:9], v[166:167] op_sel:[0,1,0] op_sel_hi:[1,1,1]
    v_pk_fma_f32 v[56:57], v[20:21], v[10:11], v[56:57] op_sel:[0,0,0] op_sel_hi:[1,0,1]
    v_pk_fma_f32 v[168:169], v[24:25], v[10:11], v[168:169] op_sel:[0,0,0] op_sel_hi:[1,0,1]
    v_pk_fma_f32 v[58:59], v[22:23], v[10:11], v[58:59] op_sel:[0,0,0] op_sel_hi:[1,0,1]
    v_pk_fma_f32 v[170:171], v[26:27], v[10:11], v[170:171] op_sel:[0,0,0] op_sel_hi:[1,0,1]
    v_pk_fma_f32 v[60:61], v[20:21], v[10:11], v[60:61] op_sel:[0,1,0] op_sel_hi:[1,1,1]
    v_pk_fma_f32 v[172:173], v[24:25], v[10:11], v[172:173] op_sel:[0,1,0] op_sel_hi:[1,1,1]
    v_pk_fma_f32 v[62:63], v[22:23], v[10:11], v[62:63] op_sel:[0,1,0] op_sel_hi:[1,1,1]
    v_pk_fma_f32 v[174:175], v[26:27], v[10:11], v[174:175] op_sel:[0,1,0] op_sel_hi:[1,1,1]
    ds_read_b128 v[20:23], v30 offset:128
    ds_read_b128 v[24:27], v30 offset:576
    v_pk_mul_f32 v[48:49], v[48:49], v[16:17] op_sel:[0,0] op_sel_hi:[1,0]
    v_pk_mul_f32 v[50:51], v[50:51], v[16:17] op_sel:[0,0] op_sel_hi:[1,0]
    v_pk_mul_f32 v[52:53], v[52:53], v[16:17] op_sel:[0,1] op_sel_hi:[1,1]
    v_pk_mul_f32 v[54:55], v[54:55], v[16:17] op_sel:[0,1] op_sel_hi:[1,1]
    v_pk_mul_f32 v[56:57], v[56:57], v[18:19] op_sel:[0,0] op_sel_hi:[1,0]
    v_pk_mul_f32 v[58:59], v[58:59], v[18:19] op_sel:[0,0] op_sel_hi:[1,0]
    v_pk_mul_f32 v[60:61], v[60:61], v[18:19] op_sel:[0,1] op_sel_hi:[1,1]
    v_pk_mul_f32 v[62:63], v[62:63], v[18:19] op_sel:[0,1] op_sel_hi:[1,1]
    v_exp_f32 v48, v48
    v_exp_f32 v49, v49
    v_exp_f32 v50, v50
    v_exp_f32 v51, v51
    v_exp_f32 v52, v52
    v_exp_f32 v53, v53
    v_exp_f32 v54, v54
    v_exp_f32 v55, v55
    v_exp_f32 v56, v56
    v_exp_f32 v57, v57
    v_exp_f32 v58, v58
    v_exp_f32 v59, v59
    v_exp_f32 v60, v60
    v_exp_f32 v61, v61
    v_exp_f32 v62, v62
    v_exp_f32 v63, v63
    v_pk_fma_f32 v[48:49], v[48:49], v[12:13], v[12:13] op_sel:[0,0,0] op_sel_hi:[1,0,0]
    v_pk_fma_f32 v[50:51], v[50:51], v[12:13], v[12:13] op_sel:[0,0,0] op_sel_hi:[1,0,0]
    v_pk_fma_f32 v[52:53], v[52:53], v[12:13], v[12:13] op_sel:[0,1,1] op_sel_hi:[1,1,1]
    v_pk_fma_f32 v[54:55], v[54:55], v[12:13], v[12:13] op_sel:[0,1,1] op_sel_hi:[1,1,1]
    v_pk_fma_f32 v[56:57], v[56:57], v[14:15], v[14:15] op_sel:[0,0,0] op_sel_hi:[1,0,0]
    v_pk_fma_f32 v[58:59], v[58:59], v[14:15], v[14:15] op_sel:[0,0,0] op_sel_hi:[1,0,0]
    v_pk_fma_f32 v[60:61], v[60:61], v[14:15], v[14:15] op_sel:[0,1,1] op_sel_hi:[1,1,1]
    v_pk_fma_f32 v[62:63], v[62:63], v[14:15], v[14:15] op_sel:[0,1,1] op_sel_hi:[1,1,1]
    v_rcp_f32 v48, v48
    v_rcp_f32 v49, v49
    v_rcp_f32 v50, v50
    v_rcp_f32 v51, v51
    v_rcp_f32 v52, v52
    v_rcp_f32 v53, v53
    v_rcp_f32 v54, v54
    v_rcp_f32 v55, v55
    v_rcp_f32 v56, v56
    v_rcp_f32 v57, v57
    v_rcp_f32 v58, v58
    v_rcp_f32 v59, v59
    v_rcp_f32 v60, v60
    v_rcp_f32 v61, v61
    v_rcp_f32 v62, v62
    v_rcp_f32 v63, v63
    v_pk_mul_f32 v[48:49], v[48:49], v[160:161] op_sel:[0,0] op_sel_hi:[1,1]
    v_pk_mul_f32 v[50:51], v[50:51], v[162:163] op_sel:[0,0] op_sel_hi:[1,1]
    v_pk_mul_f32 v[52:53], v[52:53], v[164:165] op_sel:[0,0] op_sel_hi:[1,1]
    v_pk_mul_f32 v[54:55], v[54:55], v[166:167] op_sel:[0,0] op_sel_hi:[1,1]
    v_pk_mul_f32 v[56:57], v[56:57], v[168:169] op_sel:[0,0] op_sel_hi:[1,1]
    v_pk_mul_f32 v[58:59], v[58:59], v[170:171] op_sel:[0,0] op_sel_hi:[1,1]
    v_pk_mul_f32 v[60:61], v[60:61], v[172:173] op_sel:[0,0] op_sel_hi:[1,1]
    v_pk_mul_f32 v[62:63], v[62:63], v[174:175] op_sel:[0,0] op_sel_hi:[1,1]
    v_cvt_pk_bf16_f32 v48, v48, v49
    v_cvt_pk_bf16_f32 v49, v50, v51
    v_cvt_pk_bf16_f32 v50, v52, v53
    v_cvt_pk_bf16_f32 v51, v54, v55
    v_cvt_pk_bf16_f32 v56, v56, v57
    v_cvt_pk_bf16_f32 v57, v58, v59
    v_cvt_pk_bf16_f32 v58, v60, v61
    v_cvt_pk_bf16_f32 v59, v62, v63
    v_permlane32_swap_b32 v48, v50
    v_permlane32_swap_b32 v49, v51
    buffer_store_dwordx4 v[48:51], v29, s[12:15], s48 offen offset:0 sc1
    s_nop 0
    v_permlane32_swap_b32 v56, v58
    v_permlane32_swap_b32 v57, v59
    buffer_store_dwordx4 v[56:59], v29, s[12:15], s48 offen offset:2048 sc1
    s_add_u32 s47, s46, 2
    s_lshr_b32 s48, s47, 1
    s_lshl_b32 s48, s48, 12
    s_and_b32 s47, s47, 1
    s_lshl_b32 s47, s47, 9
    s_add_u32 s48, s48, s47
    s_add_u32 s48, s48, s45
    s_waitcnt lgkmcnt(0)
    v_pk_fma_f32 v[64:65], v[20:21], v[8:9], v[64:65] op_sel:[0,0,0] op_sel_hi:[1,0,1]
    v_pk_fma_f32 v[176:177], v[24:25], v[8:9], v[176:177] op_sel:[0,0,0] op_sel_hi:[1,0,1]
    v_pk_fma_f32 v[66:67], v[22:23], v[8:9], v[66:67] op_sel:[0,0,0] op_sel_hi:[1,0,1]
    v_pk_fma_f32 v[178:179], v[26:27], v[8:9], v[178:179] op_sel:[0,0,0] op_sel_hi:[1,0,1]
    v_pk_fma_f32 v[68:69], v[20:21], v[8:9], v[68:69] op_sel:[0,1,0] op_sel_hi:[1,1,1]
    v_pk_fma_f32 v[180:181], v[24:25], v[8:9], v[180:181] op_sel:[0,1,0] op_sel_hi:[1,1,1]
    v_pk_fma_f32 v[70:71], v[22:23], v[8:9], v[70:71] op_sel:[0,1,0] op_sel_hi:[1,1,1]
    v_pk_fma_f32 v[182:183], v[26:27], v[8:9], v[182:183] op_sel:[0,1,0] op_sel_hi:[1,1,1]
    v_pk_fma_f32 v[72:73], v[20:21], v[10:11], v[72:73] op_sel:[0,0,0] op_sel_hi:[1,0,1]
    v_pk_fma_f32 v[184:185], v[24:25], v[10:11], v[184:185] op_sel:[0,0,0] op_sel_hi:[1,0,1]
    v_pk_fma_f32 v[74:75], v[22:23], v[10:11], v[74:75] op_sel:[0,0,0] op_sel_hi:[1,0,1]
    v_pk_fma_f32 v[186:187], v[26:27], v[10:11], v[186:187] op_sel:[0,0,0] op_sel_hi:[1,0,1]
    v_pk_fma_f32 v[76:77], v[20:21], v[10:11], v[76:77] op_sel:[0,1,0] op_sel_hi:[1,1,1]
    v_pk_fma_f32 v[188:189], v[24:25], v[10:11], v[188:189] op_sel:[0,1,0] op_sel_hi:[1,1,1]
    v_pk_fma_f32 v[78:79], v[22:23], v[10:11], v[78:79] op_sel:[0,1,0] op_sel_hi:[1,1,1]
    v_pk_fma_f32 v[190:191], v[26:27], v[10:11], v[190:191] op_sel:[0,1,0] op_sel_hi:[1,1,1]
    ds_read_b128 v[20:23], v30 offset:192
    ds_read_b128 v[24:27], v30 offset:640
    v_pk_mul_f32 v[64:65], v[64:65], v[16:17] op_sel:[0,0] op_sel_hi:[1,0]
    v_pk_mul_f32 v[66:67], v[66:67], v[16:17] op_sel:[0,0] op_sel_hi:[1,0]
    v_pk_mul_f32 v[68:69], v[68:69], v[16:17] op_sel:[0,1] op_sel_hi:[1,1]
    v_pk_mul_f32 v[70:71], v[70:71], v[16:17] op_sel:[0,1] op_sel_hi:[1,1]
    v_pk_mul_f32 v[72:73], v[72:73], v[18:19] op_sel:[0,0] op_sel_hi:[1,0]
    v_pk_mul_f32 v[74:75], v[74:75], v[18:19] op_sel:[0,0] op_sel_hi:[1,0]
    v_pk_mul_f32 v[76:77], v[76:77], v[18:19] op_sel:[0,1] op_sel_hi:[1,1]
    v_pk_mul_f32 v[78:79], v[78:79], v[18:19] op_sel:[0,1] op_sel_hi:[1,1]
    v_exp_f32 v64, v64
    v_exp_f32 v65, v65
    v_exp_f32 v66, v66
    v_exp_f32 v67, v67
    v_exp_f32 v68, v68
    v_exp_f32 v69, v69
    v_exp_f32 v70, v70
    v_exp_f32 v71, v71
    v_exp_f32 v72, v72
    v_exp_f32 v73, v73
    v_exp_f32 v74, v74
    v_exp_f32 v75, v75
    v_exp_f32 v76, v76
    v_exp_f32 v77, v77
    v_exp_f32 v78, v78
    v_exp_f32 v79, v79
    v_pk_fma_f32 v[64:65], v[64:65], v[12:13], v[12:13] op_sel:[0,0,0] op_sel_hi:[1,0,0]
    v_pk_fma_f32 v[66:67], v[66:67], v[12:13], v[12:13] op_sel:[0,0,0] op_sel_hi:[1,0,0]
    v_pk_fma_f32 v[68:69], v[68:69], v[12:13], v[12:13] op_sel:[0,1,1] op_sel_hi:[1,1,1]
    v_pk_fma_f32 v[70:71], v[70:71], v[12:13], v[12:13] op_sel:[0,1,1] op_sel_hi:[1,1,1]
    v_pk_fma_f32 v[72:73], v[72:73], v[14:15], v[14:15] op_sel:[0,0,0] op_sel_hi:[1,0,0]
    v_pk_fma_f32 v[74:75], v[74:75], v[14:15], v[14:15] op_sel:[0,0,0] op_sel_hi:[1,0,0]
    v_pk_fma_f32 v[76:77], v[76:77], v[14:15], v[14:15] op_sel:[0,1,1] op_sel_hi:[1,1,1]
    v_pk_fma_f32 v[78:79], v[78:79], v[14:15], v[14:15] op_sel:[0,1,1] op_sel_hi:[1,1,1]
    v_rcp_f32 v64, v64
    v_rcp_f32 v65, v65
    v_rcp_f32 v66, v66
    v_rcp_f32 v67, v67
    v_rcp_f32 v68, v68
    v_rcp_f32 v69, v69
    v_rcp_f32 v70, v70
    v_rcp_f32 v71, v71
    v_rcp_f32 v72, v72
    v_rcp_f32 v73, v73
    v_rcp_f32 v74, v74
    v_rcp_f32 v75, v75
    v_rcp_f32 v76, v76
    v_rcp_f32 v77, v77
    v_rcp_f32 v78, v78
    v_rcp_f32 v79, v79
    v_pk_mul_f32 v[64:65], v[64:65], v[176:177] op_sel:[0,0] op_sel_hi:[1,1]
    v_pk_mul_f32 v[66:67], v[66:67], v[178:179] op_sel:[0,0] op_sel_hi:[1,1]
    v_pk_mul_f32 v[68:69], v[68:69], v[180:181] op_sel:[0,0] op_sel_hi:[1,1]
    v_pk_mul_f32 v[70:71], v[70:71], v[182:183] op_sel:[0,0] op_sel_hi:[1,1]
    v_pk_mul_f32 v[72:73], v[72:73], v[184:185] op_sel:[0,0] op_sel_hi:[1,1]
    v_pk_mul_f32 v[74:75], v[74:75], v[186:187] op_sel:[0,0] op_sel_hi:[1,1]
    v_pk_mul_f32 v[76:77], v[76:77], v[188:189] op_sel:[0,0] op_sel_hi:[1,1]
    v_pk_mul_f32 v[78:79], v[78:79], v[190:191] op_sel:[0,0] op_sel_hi:[1,1]
    v_cvt_pk_bf16_f32 v64, v64, v65
    v_cvt_pk_bf16_f32 v65, v66, v67
    v_cvt_pk_bf16_f32 v66, v68, v69
    v_cvt_pk_bf16_f32 v67, v70, v71
    v_cvt_pk_bf16_f32 v72, v72, v73
    v_cvt_pk_bf16_f32 v73, v74, v75
    v_cvt_pk_bf16_f32 v74, v76, v77
    v_cvt_pk_bf16_f32 v75, v78, v79
    v_permlane32_swap_b32 v64, v66
    v_permlane32_swap_b32 v65, v67
    buffer_store_dwordx4 v[64:67], v29, s[12:15], s48 offen offset:0 sc1
    s_nop 0
    v_permlane32_swap_b32 v72, v74
    v_permlane32_swap_b32 v73, v75
    buffer_store_dwordx4 v[72:75], v29, s[12:15], s48 offen offset:2048 sc1
    s_add_u32 s47, s46, 3
    s_lshr_b32 s48, s47, 1
    s_lshl_b32 s48, s48, 12
    s_and_b32 s47, s47, 1
    s_lshl_b32 s47, s47, 9
    s_add_u32 s48, s48, s47
    s_add_u32 s48, s48, s45
    s_waitcnt lgkmcnt(0)
    v_pk_fma_f32 v[80:81], v[20:21], v[8:9], v[80:81] op_sel:[0,0,0] op_sel_hi:[1,0,1]
    v_pk_fma_f32 v[192:193], v[24:25], v[8:9], v[192:193] op_sel:[0,0,0] op_sel_hi:[1,0,1]
    v_pk_fma_f32 v[82:83], v[22:23], v[8:9], v[82:83] op_sel:[0,0,0] op_sel_hi:[1,0,1]
    v_pk_fma_f32 v[194:195], v[26:27], v[8:9], v[194:195] op_sel:[0,0,0] op_sel_hi:[1,0,1]
    v_pk_fma_f32 v[84:85], v[20:21], v[8:9], v[84:85] op_sel:[0,1,0] op_sel_hi:[1,1,1]
    v_pk_fma_f32 v[196:197], v[24:25], v[8:9], v[196:197] op_sel:[0,1,0] op_sel_hi:[1,1,1]
    v_pk_fma_f32 v[86:87], v[22:23], v[8:9], v[86:87] op_sel:[0,1,0] op_sel_hi:[1,1,1]
    v_pk_fma_f32 v[198:199], v[26:27], v[8:9], v[198:199] op_sel:[0,1,0] op_sel_hi:[1,1,1]
    v_pk_fma_f32 v[88:89], v[20:21], v[10:11], v[88:89] op_sel:[0,0,0] op_sel_hi:[1,0,1]
    v_pk_fma_f32 v[200:201], v[24:25], v[10:11], v[200:201] op_sel:[0,0,0] op_sel_hi:[1,0,1]
    v_pk_fma_f32 v[90:91], v[22:23], v[10:11], v[90:91] op_sel:[0,0,0] op_sel_hi:[1,0,1]
    v_pk_fma_f32 v[202:203], v[26:27], v[10:11], v[202:203] op_sel:[0,0,0] op_sel_hi:[1,0,1]
    v_pk_fma_f32 v[92:93], v[20:21], v[10:11], v[92:93] op_sel:[0,1,0] op_sel_hi:[1,1,1]
    v_pk_fma_f32 v[204:205], v[24:25], v[10:11], v[204:205] op_sel:[0,1,0] op_sel_hi:[1,1,1]
    v_pk_fma_f32 v[94:95], v[22:23], v[10:11], v[94:95] op_sel:[0,1,0] op_sel_hi:[1,1,1]
    v_pk_fma_f32 v[206:207], v[26:27], v[10:11], v[206:207] op_sel:[0,1,0] op_sel_hi:[1,1,1]
    ds_read_b128 v[20:23], v30 offset:256
    ds_read_b128 v[24:27], v30 offset:704
    v_pk_mul_f32 v[80:81], v[80:81], v[16:17] op_sel:[0,0] op_sel_hi:[1,0]
    v_pk_mul_f32 v[82:83], v[82:83], v[16:17] op_sel:[0,0] op_sel_hi:[1,0]
    v_pk_mul_f32 v[84:85], v[84:85], v[16:17] op_sel:[0,1] op_sel_hi:[1,1]
    v_pk_mul_f32 v[86:87], v[86:87], v[16:17] op_sel:[0,1] op_sel_hi:[1,1]
    v_pk_mul_f32 v[88:89], v[88:89], v[18:19] op_sel:[0,0] op_sel_hi:[1,0]
    v_pk_mul_f32 v[90:91], v[90:91], v[18:19] op_sel:[0,0] op_sel_hi:[1,0]
    v_pk_mul_f32 v[92:93], v[92:93], v[18:19] op_sel:[0,1] op_sel_hi:[1,1]
    v_pk_mul_f32 v[94:95], v[94:95], v[18:19] op_sel:[0,1] op_sel_hi:[1,1]
    v_exp_f32 v80, v80
    v_exp_f32 v81, v81
    v_exp_f32 v82, v82
    v_exp_f32 v83, v83
    v_exp_f32 v84, v84
    v_exp_f32 v85, v85
    v_exp_f32 v86, v86
    v_exp_f32 v87, v87
    v_exp_f32 v88, v88
    v_exp_f32 v89, v89
    v_exp_f32 v90, v90
    v_exp_f32 v91, v91
    v_exp_f32 v92, v92
    v_exp_f32 v93, v93
    v_exp_f32 v94, v94
    v_exp_f32 v95, v95
    v_pk_fma_f32 v[80:81], v[80:81], v[12:13], v[12:13] op_sel:[0,0,0] op_sel_hi:[1,0,0]
    v_pk_fma_f32 v[82:83], v[82:83], v[12:13], v[12:13] op_sel:[0,0,0] op_sel_hi:[1,0,0]
    v_pk_fma_f32 v[84:85], v[84:85], v[12:13], v[12:13] op_sel:[0,1,1] op_sel_hi:[1,1,1]
    v_pk_fma_f32 v[86:87], v[86:87], v[12:13], v[12:13] op_sel:[0,1,1] op_sel_hi:[1,1,1]
    v_pk_fma_f32 v[88:89], v[88:89], v[14:15], v[14:15] op_sel:[0,0,0] op_sel_hi:[1,0,0]
    v_pk_fma_f32 v[90:91], v[90:91], v[14:15], v[14:15] op_sel:[0,0,0] op_sel_hi:[1,0,0]
    v_pk_fma_f32 v[92:93], v[92:93], v[14:15], v[14:15] op_sel:[0,1,1] op_sel_hi:[1,1,1]
    v_pk_fma_f32 v[94:95], v[94:95], v[14:15], v[14:15] op_sel:[0,1,1] op_sel_hi:[1,1,1]
    v_rcp_f32 v80, v80
    v_rcp_f32 v81, v81
    v_rcp_f32 v82, v82
    v_rcp_f32 v83, v83
    v_rcp_f32 v84, v84
    v_rcp_f32 v85, v85
    v_rcp_f32 v86, v86
    v_rcp_f32 v87, v87
    v_rcp_f32 v88, v88
    v_rcp_f32 v89, v89
    v_rcp_f32 v90, v90
    v_rcp_f32 v91, v91
    v_rcp_f32 v92, v92
    v_rcp_f32 v93, v93
    v_rcp_f32 v94, v94
    v_rcp_f32 v95, v95
    v_pk_mul_f32 v[80:81], v[80:81], v[192:193] op_sel:[0,0] op_sel_hi:[1,1]
    v_pk_mul_f32 v[82:83], v[82:83], v[194:195] op_sel:[0,0] op_sel_hi:[1,1]
    v_pk_mul_f32 v[84:85], v[84:85], v[196:197] op_sel:[0,0] op_sel_hi:[1,1]
    v_pk_mul_f32 v[86:87], v[86:87], v[198:199] op_sel:[0,0] op_sel_hi:[1,1]
    v_pk_mul_f32 v[88:89], v[88:89], v[200:201] op_sel:[0,0] op_sel_hi:[1,1]
    v_pk_mul_f32 v[90:91], v[90:91], v[202:203] op_sel:[0,0] op_sel_hi:[1,1]
    v_pk_mul_f32 v[92:93], v[92:93], v[204:205] op_sel:[0,0] op_sel_hi:[1,1]
    v_pk_mul_f32 v[94:95], v[94:95], v[206:207] op_sel:[0,0] op_sel_hi:[1,1]
    v_cvt_pk_bf16_f32 v80, v80, v81
    v_cvt_pk_bf16_f32 v81, v82, v83
    v_cvt_pk_bf16_f32 v82, v84, v85
    v_cvt_pk_bf16_f32 v83, v86, v87
    v_cvt_pk_bf16_f32 v88, v88, v89
    v_cvt_pk_bf16_f32 v89, v90, v91
    v_cvt_pk_bf16_f32 v90, v92, v93
    v_cvt_pk_bf16_f32 v91, v94, v95
    v_permlane32_swap_b32 v80, v82
    v_permlane32_swap_b32 v81, v83
    buffer_store_dwordx4 v[80:83], v29, s[12:15], s48 offen offset:0 sc1
    s_nop 0
    v_permlane32_swap_b32 v88, v90
    v_permlane32_swap_b32 v89, v91
    buffer_store_dwordx4 v[88:91], v29, s[12:15], s48 offen offset:2048 sc1
    s_add_u32 s47, s46, 4
    s_lshr_b32 s48, s47, 1
    s_lshl_b32 s48, s48, 12
    s_and_b32 s47, s47, 1
    s_lshl_b32 s47, s47, 9
    s_add_u32 s48, s48, s47
    s_add_u32 s48, s48, s45
    s_waitcnt lgkmcnt(0)
    v_pk_fma_f32 v[96:97], v[20:21], v[8:9], v[96:97] op_sel:[0,0,0] op_sel_hi:[1,0,1]
    v_pk_fma_f32 v[208:209], v[24:25], v[8:9], v[208:209] op_sel:[0,0,0] op_sel_hi:[1,0,1]
    v_pk_fma_f32 v[98:99], v[22:23], v[8:9], v[98:99] op_sel:[0,0,0] op_sel_hi:[1,0,1]
    v_pk_fma_f32 v[210:211], v[26:27], v[8:9], v[210:211] op_sel:[0,0,0] op_sel_hi:[1,0,1]
    v_pk_fma_f32 v[100:101], v[20:21], v[8:9], v[100:101] op_sel:[0,1,0] op_sel_hi:[1,1,1]
    v_pk_fma_f32 v[212:213], v[24:25], v[8:9], v[212:213] op_sel:[0,1,0] op_sel_hi:[1,1,1]
    v_pk_fma_f32 v[102:103], v[22:23], v[8:9], v[102:103] op_sel:[0,1,0] op_sel_hi:[1,1,1]
    v_pk_fma_f32 v[214:215], v[26:27], v[8:9], v[214:215] op_sel:[0,1,0] op_sel_hi:[1,1,1]
    v_pk_fma_f32 v[104:105], v[20:21], v[10:11], v[104:105] op_sel:[0,0,0] op_sel_hi:[1,0,1]
    v_pk_fma_f32 v[216:217], v[24:25], v[10:11], v[216:217] op_sel:[0,0,0] op_sel_hi:[1,0,1]
    v_pk_fma_f32 v[106:107], v[22:23], v[10:11], v[106:107] op_sel:[0,0,0] op_sel_hi:[1,0,1]
    v_pk_fma_f32 v[218:219], v[26:27], v[10:11], v[218:219] op_sel:[0,0,0] op_sel_hi:[1,0,1]
    v_pk_fma_f32 v[108:109], v[20:21], v[10:11], v[108:109] op_sel:[0,1,0] op_sel_hi:[1,1,1]
    v_pk_fma_f32 v[220:221], v[24:25], v[10:11], v[220:221] op_sel:[0,1,0] op_sel_hi:[1,1,1]
    v_pk_fma_f32 v[110:111], v[22:23], v[10:11], v[110:111] op_sel:[0,1,0] op_sel_hi:[1,1,1]
    v_pk_fma_f32 v[222:223], v[26:27], v[10:11], v[222:223] op_sel:[0,1,0] op_sel_hi:[1,1,1]
    ds_read_b128 v[20:23], v30 offset:320
    ds_read_b128 v[24:27], v30 offset:768
    v_pk_mul_f32 v[96:97], v[96:97], v[16:17] op_sel:[0,0] op_sel_hi:[1,0]
    v_pk_mul_f32 v[98:99], v[98:99], v[16:17] op_sel:[0,0] op_sel_hi:[1,0]
    v_pk_mul_f32 v[100:101], v[100:101], v[16:17] op_sel:[0,1] op_sel_hi:[1,1]
    v_pk_mul_f32 v[102:103], v[102:103], v[16:17] op_sel:[0,1] op_sel_hi:[1,1]
    v_pk_mul_f32 v[104:105], v[104:105], v[18:19] op_sel:[0,0] op_sel_hi:[1,0]
    v_pk_mul_f32 v[106:107], v[106:107], v[18:19] op_sel:[0,0] op_sel_hi:[1,0]
    v_pk_mul_f32 v[108:109], v[108:109], v[18:19] op_sel:[0,1] op_sel_hi:[1,1]
    v_pk_mul_f32 v[110:111], v[110:111], v[18:19] op_sel:[0,1] op_sel_hi:[1,1]
    v_exp_f32 v96, v96
    v_exp_f32 v97, v97
    v_exp_f32 v98, v98
    v_exp_f32 v99, v99
    v_exp_f32 v100, v100
    v_exp_f32 v101, v101
    v_exp_f32 v102, v102
    v_exp_f32 v103, v103
    v_exp_f32 v104, v104
    v_exp_f32 v105, v105
    v_exp_f32 v106, v106
    v_exp_f32 v107, v107
    v_exp_f32 v108, v108
    v_exp_f32 v109, v109
    v_exp_f32 v110, v110
    v_exp_f32 v111, v111
    v_pk_fma_f32 v[96:97], v[96:97], v[12:13], v[12:13] op_sel:[0,0,0] op_sel_hi:[1,0,0]
    v_pk_fma_f32 v[98:99], v[98:99], v[12:13], v[12:13] op_sel:[0,0,0] op_sel_hi:[1,0,0]
    v_pk_fma_f32 v[100:101], v[100:101], v[12:13], v[12:13] op_sel:[0,1,1] op_sel_hi:[1,1,1]
    v_pk_fma_f32 v[102:103], v[102:103], v[12:13], v[12:13] op_sel:[0,1,1] op_sel_hi:[1,1,1]
    v_pk_fma_f32 v[104:105], v[104:105], v[14:15], v[14:15] op_sel:[0,0,0] op_sel_hi:[1,0,0]
    v_pk_fma_f32 v[106:107], v[106:107], v[14:15], v[14:15] op_sel:[0,0,0] op_sel_hi:[1,0,0]
    v_pk_fma_f32 v[108:109], v[108:109], v[14:15], v[14:15] op_sel:[0,1,1] op_sel_hi:[1,1,1]
    v_pk_fma_f32 v[110:111], v[110:111], v[14:15], v[14:15] op_sel:[0,1,1] op_sel_hi:[1,1,1]
    v_rcp_f32 v96, v96
    v_rcp_f32 v97, v97
    v_rcp_f32 v98, v98
    v_rcp_f32 v99, v99
    v_rcp_f32 v100, v100
    v_rcp_f32 v101, v101
    v_rcp_f32 v102, v102
    v_rcp_f32 v103, v103
    v_rcp_f32 v104, v104
    v_rcp_f32 v105, v105
    v_rcp_f32 v106, v106
    v_rcp_f32 v107, v107
    v_rcp_f32 v108, v108
    v_rcp_f32 v109, v109
    v_rcp_f32 v110, v110
    v_rcp_f32 v111, v111
    v_pk_mul_f32 v[96:97], v[96:97], v[208:209] op_sel:[0,0] op_sel_hi:[1,1]
    v_pk_mul_f32 v[98:99], v[98:99], v[210:211] op_sel:[0,0] op_sel_hi:[1,1]
    v_pk_mul_f32 v[100:101], v[100:101], v[212:213] op_sel:[0,0] op_sel_hi:[1,1]
    v_pk_mul_f32 v[102:103], v[102:103], v[214:215] op_sel:[0,0] op_sel_hi:[1,1]
    v_pk_mul_f32 v[104:105], v[104:105], v[216:217] op_sel:[0,0] op_sel_hi:[1,1]
    v_pk_mul_f32 v[106:107], v[106:107], v[218:219] op_sel:[0,0] op_sel_hi:[1,1]
    v_pk_mul_f32 v[108:109], v[108:109], v[220:221] op_sel:[0,0] op_sel_hi:[1,1]
    v_pk_mul_f32 v[110:111], v[110:111], v[222:223] op_sel:[0,0] op_sel_hi:[1,1]
    v_cvt_pk_bf16_f32 v96, v96, v97
    v_cvt_pk_bf16_f32 v97, v98, v99
    v_cvt_pk_bf16_f32 v98, v100, v101
    v_cvt_pk_bf16_f32 v99, v102, v103
    v_cvt_pk_bf16_f32 v104, v104, v105
    v_cvt_pk_bf16_f32 v105, v106, v107
    v_cvt_pk_bf16_f32 v106, v108, v109
    v_cvt_pk_bf16_f32 v107, v110, v111
    v_permlane32_swap_b32 v96, v98
    v_permlane32_swap_b32 v97, v99
    buffer_store_dwordx4 v[96:99], v29, s[12:15], s48 offen offset:0 sc1
    s_nop 0
    v_permlane32_swap_b32 v104, v106
    v_permlane32_swap_b32 v105, v107
    buffer_store_dwordx4 v[104:107], v29, s[12:15], s48 offen offset:2048 sc1
    s_add_u32 s47, s46, 5
    s_lshr_b32 s48, s47, 1
    s_lshl_b32 s48, s48, 12
    s_and_b32 s47, s47, 1
    s_lshl_b32 s47, s47, 9
    s_add_u32 s48, s48, s47
    s_add_u32 s48, s48, s45
    s_waitcnt lgkmcnt(0)
    v_pk_fma_f32 v[112:113], v[20:21], v[8:9], v[112:113] op_sel:[0,0,0] op_sel_hi:[1,0,1]
    v_pk_fma_f32 v[224:225], v[24:25], v[8:9], v[224:225] op_sel:[0,0,0] op_sel_hi:[1,0,1]
    v_pk_fma_f32 v[114:115], v[22:23], v[8:9], v[114:115] op_sel:[0,0,0] op_sel_hi:[1,0,1]
    v_pk_fma_f32 v[226:227], v[26:27], v[8:9], v[226:227] op_sel:[0,0,0] op_sel_hi:[1,0,1]
    v_pk_fma_f32 v[116:117], v[20:21], v[8:9], v[116:117] op_sel:[0,1,0] op_sel_hi:[1,1,1]
    v_pk_fma_f32 v[228:229], v[24:25], v[8:9], v[228:229] op_sel:[0,1,0] op_sel_hi:[1,1,1]
    v_pk_fma_f32 v[118:119], v[22:23], v[8:9], v[118:119] op_sel:[0,1,0] op_sel_hi:[1,1,1]
    v_pk_fma_f32 v[230:231], v[26:27], v[8:9], v[230:231] op_sel:[0,1,0] op_sel_hi:[1,1,1]
    v_pk_fma_f32 v[120:121], v[20:21], v[10:11], v[120:121] op_sel:[0,0,0] op_sel_hi:[1,0,1]
    v_pk_fma_f32 v[232:233], v[24:25], v[10:11], v[232:233] op_sel:[0,0,0] op_sel_hi:[1,0,1]
    v_pk_fma_f32 v[122:123], v[22:23], v[10:11], v[122:123] op_sel:[0,0,0] op_sel_hi:[1,0,1]
    v_pk_fma_f32 v[234:235], v[26:27], v[10:11], v[234:235] op_sel:[0,0,0] op_sel_hi:[1,0,1]
    v_pk_fma_f32 v[124:125], v[20:21], v[10:11], v[124:125] op_sel:[0,1,0] op_sel_hi:[1,1,1]
    v_pk_fma_f32 v[236:237], v[24:25], v[10:11], v[236:237] op_sel:[0,1,0] op_sel_hi:[1,1,1]
    v_pk_fma_f32 v[126:127], v[22:23], v[10:11], v[126:127] op_sel:[0,1,0] op_sel_hi:[1,1,1]
    v_pk_fma_f32 v[238:239], v[26:27], v[10:11], v[238:239] op_sel:[0,1,0] op_sel_hi:[1,1,1]
    ds_read_b128 v[20:23], v30 offset:384
    ds_read_b128 v[24:27], v30 offset:832
    v_pk_mul_f32 v[112:113], v[112:113], v[16:17] op_sel:[0,0] op_sel_hi:[1,0]
    v_pk_mul_f32 v[114:115], v[114:115], v[16:17] op_sel:[0,0] op_sel_hi:[1,0]
    v_pk_mul_f32 v[116:117], v[116:117], v[16:17] op_sel:[0,1] op_sel_hi:[1,1]
    v_pk_mul_f32 v[118:119], v[118:119], v[16:17] op_sel:[0,1] op_sel_hi:[1,1]
    v_pk_mul_f32 v[120:121], v[120:121], v[18:19] op_sel:[0,0] op_sel_hi:[1,0]
    v_pk_mul_f32 v[122:123], v[122:123], v[18:19] op_sel:[0,0] op_sel_hi:[1,0]
    v_pk_mul_f32 v[124:125], v[124:125], v[18:19] op_sel:[0,1] op_sel_hi:[1,1]
    v_pk_mul_f32 v[126:127], v[126:127], v[18:19] op_sel:[0,1] op_sel_hi:[1,1]
    v_exp_f32 v112, v112
    v_exp_f32 v113, v113
    v_exp_f32 v114, v114
    v_exp_f32 v115, v115
    v_exp_f32 v116, v116
    v_exp_f32 v117, v117
    v_exp_f32 v118, v118
    v_exp_f32 v119, v119
    v_exp_f32 v120, v120
    v_exp_f32 v121, v121
    v_exp_f32 v122, v122
    v_exp_f32 v123, v123
    v_exp_f32 v124, v124
    v_exp_f32 v125, v125
    v_exp_f32 v126, v126
    v_exp_f32 v127, v127
    v_pk_fma_f32 v[112:113], v[112:113], v[12:13], v[12:13] op_sel:[0,0,0] op_sel_hi:[1,0,0]
    v_pk_fma_f32 v[114:115], v[114:115], v[12:13], v[12:13] op_sel:[0,0,0] op_sel_hi:[1,0,0]
    v_pk_fma_f32 v[116:117], v[116:117], v[12:13], v[12:13] op_sel:[0,1,1] op_sel_hi:[1,1,1]
    v_pk_fma_f32 v[118:119], v[118:119], v[12:13], v[12:13] op_sel:[0,1,1] op_sel_hi:[1,1,1]
    v_pk_fma_f32 v[120:121], v[120:121], v[14:15], v[14:15] op_sel:[0,0,0] op_sel_hi:[1,0,0]
    v_pk_fma_f32 v[122:123], v[122:123], v[14:15], v[14:15] op_sel:[0,0,0] op_sel_hi:[1,0,0]
    v_pk_fma_f32 v[124:125], v[124:125], v[14:15], v[14:15] op_sel:[0,1,1] op_sel_hi:[1,1,1]
    v_pk_fma_f32 v[126:127], v[126:127], v[14:15], v[14:15] op_sel:[0,1,1] op_sel_hi:[1,1,1]
    v_rcp_f32 v112, v112
    v_rcp_f32 v113, v113
    v_rcp_f32 v114, v114
    v_rcp_f32 v115, v115
    v_rcp_f32 v116, v116
    v_rcp_f32 v117, v117
    v_rcp_f32 v118, v118
    v_rcp_f32 v119, v119
    v_rcp_f32 v120, v120
    v_rcp_f32 v121, v121
    v_rcp_f32 v122, v122
    v_rcp_f32 v123, v123
    v_rcp_f32 v124, v124
    v_rcp_f32 v125, v125
    v_rcp_f32 v126, v126
    v_rcp_f32 v127, v127
    v_pk_mul_f32 v[112:113], v[112:113], v[224:225] op_sel:[0,0] op_sel_hi:[1,1]
    v_pk_mul_f32 v[114:115], v[114:115], v[226:227] op_sel:[0,0] op_sel_hi:[1,1]
    v_pk_mul_f32 v[116:117], v[116:117], v[228:229] op_sel:[0,0] op_sel_hi:[1,1]
    v_pk_mul_f32 v[118:119], v[118:119], v[230:231] op_sel:[0,0] op_sel_hi:[1,1]
    v_pk_mul_f32 v[120:121], v[120:121], v[232:233] op_sel:[0,0] op_sel_hi:[1,1]
    v_pk_mul_f32 v[122:123], v[122:123], v[234:235] op_sel:[0,0] op_sel_hi:[1,1]
    v_pk_mul_f32 v[124:125], v[124:125], v[236:237] op_sel:[0,0] op_sel_hi:[1,1]
    v_pk_mul_f32 v[126:127], v[126:127], v[238:239] op_sel:[0,0] op_sel_hi:[1,1]
    v_cvt_pk_bf16_f32 v112, v112, v113
    v_cvt_pk_bf16_f32 v113, v114, v115
    v_cvt_pk_bf16_f32 v114, v116, v117
    v_cvt_pk_bf16_f32 v115, v118, v119
    v_cvt_pk_bf16_f32 v120, v120, v121
    v_cvt_pk_bf16_f32 v121, v122, v123
    v_cvt_pk_bf16_f32 v122, v124, v125
    v_cvt_pk_bf16_f32 v123, v126, v127
    v_permlane32_swap_b32 v112, v114
    v_permlane32_swap_b32 v113, v115
    buffer_store_dwordx4 v[112:115], v29, s[12:15], s48 offen offset:0 sc1
    s_nop 0
    v_permlane32_swap_b32 v120, v122
    v_permlane32_swap_b32 v121, v123
    buffer_store_dwordx4 v[120:123], v29, s[12:15], s48 offen offset:2048 sc1
    s_add_u32 s47, s46, 6
    s_lshr_b32 s48, s47, 1
    s_lshl_b32 s48, s48, 12
    s_and_b32 s47, s47, 1
    s_lshl_b32 s47, s47, 9
    s_add_u32 s48, s48, s47
    s_add_u32 s48, s48, s45
    s_waitcnt lgkmcnt(0)
    v_pk_fma_f32 v[128:129], v[20:21], v[8:9], v[128:129] op_sel:[0,0,0] op_sel_hi:[1,0,1]
    v_pk_fma_f32 v[240:241], v[24:25], v[8:9], v[240:241] op_sel:[0,0,0] op_sel_hi:[1,0,1]
    v_pk_fma_f32 v[130:131], v[22:23], v[8:9], v[130:131] op_sel:[0,0,0] op_sel_hi:[1,0,1]
    v_pk_fma_f32 v[242:243], v[26:27], v[8:9], v[242:243] op_sel:[0,0,0] op_sel_hi:[1,0,1]
    v_pk_fma_f32 v[132:133], v[20:21], v[8:9], v[132:133] op_sel:[0,1,0] op_sel_hi:[1,1,1]
    v_pk_fma_f32 v[244:245], v[24:25], v[8:9], v[244:245] op_sel:[0,1,0] op_sel_hi:[1,1,1]
    v_pk_fma_f32 v[134:135], v[22:23], v[8:9], v[134:135] op_sel:[0,1,0] op_sel_hi:[1,1,1]
    v_pk_fma_f32 v[246:247], v[26:27], v[8:9], v[246:247] op_sel:[0,1,0] op_sel_hi:[1,1,1]
    v_pk_fma_f32 v[136:137], v[20:21], v[10:11], v[136:137] op_sel:[0,0,0] op_sel_hi:[1,0,1]
    v_pk_fma_f32 v[248:249], v[24:25], v[10:11], v[248:249] op_sel:[0,0,0] op_sel_hi:[1,0,1]
    v_pk_fma_f32 v[138:139], v[22:23], v[10:11], v[138:139] op_sel:[0,0,0] op_sel_hi:[1,0,1]
    v_pk_fma_f32 v[250:251], v[26:27], v[10:11], v[250:251] op_sel:[0,0,0] op_sel_hi:[1,0,1]
    v_pk_fma_f32 v[140:141], v[20:21], v[10:11], v[140:141] op_sel:[0,1,0] op_sel_hi:[1,1,1]
    v_pk_fma_f32 v[252:253], v[24:25], v[10:11], v[252:253] op_sel:[0,1,0] op_sel_hi:[1,1,1]
    v_pk_fma_f32 v[142:143], v[22:23], v[10:11], v[142:143] op_sel:[0,1,0] op_sel_hi:[1,1,1]
    v_pk_fma_f32 v[254:255], v[26:27], v[10:11], v[254:255] op_sel:[0,1,0] op_sel_hi:[1,1,1]
    v_pk_mul_f32 v[128:129], v[128:129], v[16:17] op_sel:[0,0] op_sel_hi:[1,0]
    v_pk_mul_f32 v[130:131], v[130:131], v[16:17] op_sel:[0,0] op_sel_hi:[1,0]
    v_pk_mul_f32 v[132:133], v[132:133], v[16:17] op_sel:[0,1] op_sel_hi:[1,1]
    v_pk_mul_f32 v[134:135], v[134:135], v[16:17] op_sel:[0,1] op_sel_hi:[1,1]
    v_pk_mul_f32 v[136:137], v[136:137], v[18:19] op_sel:[0,0] op_sel_hi:[1,0]
    v_pk_mul_f32 v[138:139], v[138:139], v[18:19] op_sel:[0,0] op_sel_hi:[1,0]
    v_pk_mul_f32 v[140:141], v[140:141], v[18:19] op_sel:[0,1] op_sel_hi:[1,1]
    v_pk_mul_f32 v[142:143], v[142:143], v[18:19] op_sel:[0,1] op_sel_hi:[1,1]
    v_exp_f32 v128, v128
    v_exp_f32 v129, v129
    v_exp_f32 v130, v130
    v_exp_f32 v131, v131
    v_exp_f32 v132, v132
    v_exp_f32 v133, v133
    v_exp_f32 v134, v134
    v_exp_f32 v135, v135
    v_exp_f32 v136, v136
    v_exp_f32 v137, v137
    v_exp_f32 v138, v138
    v_exp_f32 v139, v139
    v_exp_f32 v140, v140
    v_exp_f32 v141, v141
    v_exp_f32 v142, v142
    v_exp_f32 v143, v143
    v_pk_fma_f32 v[128:129], v[128:129], v[12:13], v[12:13] op_sel:[0,0,0] op_sel_hi:[1,0,0]
    v_pk_fma_f32 v[130:131], v[130:131], v[12:13], v[12:13] op_sel:[0,0,0] op_sel_hi:[1,0,0]
    v_pk_fma_f32 v[132:133], v[132:133], v[12:13], v[12:13] op_sel:[0,1,1] op_sel_hi:[1,1,1]
    v_pk_fma_f32 v[134:135], v[134:135], v[12:13], v[12:13] op_sel:[0,1,1] op_sel_hi:[1,1,1]
    v_pk_fma_f32 v[136:137], v[136:137], v[14:15], v[14:15] op_sel:[0,0,0] op_sel_hi:[1,0,0]
    v_pk_fma_f32 v[138:139], v[138:139], v[14:15], v[14:15] op_sel:[0,0,0] op_sel_hi:[1,0,0]
    v_pk_fma_f32 v[140:141], v[140:141], v[14:15], v[14:15] op_sel:[0,1,1] op_sel_hi:[1,1,1]
    v_pk_fma_f32 v[142:143], v[142:143], v[14:15], v[14:15] op_sel:[0,1,1] op_sel_hi:[1,1,1]
    v_rcp_f32 v128, v128
    v_rcp_f32 v129, v129
    v_rcp_f32 v130, v130
    v_rcp_f32 v131, v131
    v_rcp_f32 v132, v132
    v_rcp_f32 v133, v133
    v_rcp_f32 v134, v134
    v_rcp_f32 v135, v135
    v_rcp_f32 v136, v136
    v_rcp_f32 v137, v137
    v_rcp_f32 v138, v138
    v_rcp_f32 v139, v139
    v_rcp_f32 v140, v140
    v_rcp_f32 v141, v141
    v_rcp_f32 v142, v142
    v_rcp_f32 v143, v143
    v_pk_mul_f32 v[128:129], v[128:129], v[240:241] op_sel:[0,0] op_sel_hi:[1,1]
    v_pk_mul_f32 v[130:131], v[130:131], v[242:243] op_sel:[0,0] op_sel_hi:[1,1]
    v_pk_mul_f32 v[132:133], v[132:133], v[244:245] op_sel:[0,0] op_sel_hi:[1,1]
    v_pk_mul_f32 v[134:135], v[134:135], v[246:247] op_sel:[0,0] op_sel_hi:[1,1]
    v_pk_mul_f32 v[136:137], v[136:137], v[248:249] op_sel:[0,0] op_sel_hi:[1,1]
    v_pk_mul_f32 v[138:139], v[138:139], v[250:251] op_sel:[0,0] op_sel_hi:[1,1]
    v_pk_mul_f32 v[140:141], v[140:141], v[252:253] op_sel:[0,0] op_sel_hi:[1,1]
    v_pk_mul_f32 v[142:143], v[142:143], v[254:255] op_sel:[0,0] op_sel_hi:[1,1]
    v_cvt_pk_bf16_f32 v128, v128, v129
    v_cvt_pk_bf16_f32 v129, v130, v131
    v_cvt_pk_bf16_f32 v130, v132, v133
    v_cvt_pk_bf16_f32 v131, v134, v135
    v_cvt_pk_bf16_f32 v136, v136, v137
    v_cvt_pk_bf16_f32 v137, v138, v139
    v_cvt_pk_bf16_f32 v138, v140, v141
    v_cvt_pk_bf16_f32 v139, v142, v143
    v_permlane32_swap_b32 v128, v130
    v_permlane32_swap_b32 v129, v131
    buffer_store_dwordx4 v[128:131], v29, s[12:15], s48 offen offset:0 sc1
    s_nop 0
    v_permlane32_swap_b32 v136, v138
    v_permlane32_swap_b32 v137, v139
    buffer_store_dwordx4 v[136:139], v29, s[12:15], s48 offen offset:2048 sc1
    s_add_u32 s92, s40, 48
    v_lshrrev_b32 v2, 4, v1
    v_and_b32 v3, 15, v1
    s_and_b32 s40, s38, 3
    s_lshl_b32 s40, s40, 3
    s_and_b32 s45, s39, 7
    s_add_u32 s40, s40, s45
    s_lshr_b32 s41, s38, 2
    s_lshl_b32 s41, s41, 2
    s_lshr_b32 s45, s39, 3
    s_add_u32 s41, s41, s45
    s_lshr_b32 s43, s42, 1
    s_and_b32 s44, s42, 1
    v_lshlrev_b32 v4, 4, v1
    s_lshr_b32 s45, s42, 1
    s_xor_b32 s45, s45, s40
    s_lshl_b32 s45, s45, 1
    s_and_b32 s21, s40, 1
    s_add_u32 s45, s45, s21
    s_mul_i32 s31, s45, 229376
    s_and_b32 s46, s42, 1
    s_lshl_b32 s16, s46, 12
    s_lshl_b32 s18, s42, 12
    s_lshl_b32 s45, s43, 11
    v_add_u32 v24, s45, v4
    s_mul_i32 s21, s21, 3670016
    v_lshrrev_b32 v20, 3, v1
    v_and_b32 v21, 7, v1
    v_and_b32 v22, 6, v20
    v_xor_b32 v21, v21, v22
    v_lshlrev_b32 v21, 4, v21
    v_mul_u32_u24 v20, 2048, v20
    v_add_u32 v20, v20, v21
    s_mul_i32 s17, s42, 32768
    s_mul_i32 s45, s41, 256
    s_add_u32 s17, s17, s45
    s_mul_i32 s19, s42, 4096
    s_add_u32 s19, s19, 16384
    v_add_u32 v8, 4096, v20
    v_add_u32 v9, 3200, v20
    v_add_u32 v10, 18432, v20
    v_add_u32 v11, 17536, v20
    s_sub_u32 s17, s17, 131072
    s_sub_u32 s16, s16, 8192
    s_add_u32 s4, s82, 25165824
    s_addc_u32 s5, s83, 0
    s_and_b32 s5, s5, 0xffff
    s_mov_b32 s6, 7340032
    s_mov_b32 s7, 0x20000
    s_sub_u32 s8, s76, 4096
    s_subb_u32 s9, s77, 0
    s_and_b32 s9, s9, 0xffff
    s_mov_b32 s10, 3674112
    s_mov_b32 s11, 0x20000
    s_add_u32 s12, s82, 20971520
    s_addc_u32 s13, s83, 0
    s_and_b32 s13, s13, 0xffff
    s_mov_b32 s14, 4194304
    s_mov_b32 s15, 0x20000
    s_mov_b32 s52, s78
    s_and_b32 s53, s79, 0xffff
    s_mov_b32 s54, 4194304
    s_mov_b32 s55, 0x20000
    s_add_u32 s56, s82, 8388608
    s_addc_u32 s57, s83, 0
    s_and_b32 s57, s57, 0xffff
    s_mov_b32 s58, 8388608
    s_mov_b32 s59, 0x20000
    s_add_u32 s17, s17, s21
    s_add_u32 s10, s10, s21
    s_add_u32 s4, s4, s31
    s_addc_u32 s5, s5, 0
    s_mov_b32 s6, 229376
    s_waitcnt vmcnt(0)
    s_barrier
    s_cmp_lg_u32 s42, 0
    s_cbranch_scc1 sequential_preLN__softmax_full_mha__glu_gated_glu__prompt_kernel_b9a
    s_lshl_b32 s92, s92, 8
    v_mov_b32 v30, s92
    v_mov_b32 v31, 1
    s_mov_b64 exec, 1
    buffer_atomic_add v31, v30, s[84:87], 0 offen sc1
    s_mov_b64 exec, -1
sequential_preLN__softmax_full_mha__glu_gated_glu__prompt_kernel_b9a:
    s_add_u32 m0, s19, 0
    s_add_u32 s17, s17, 131072
    buffer_load_dwordx4 v8, s[8:11], s17 offen offset:0 lds
    buffer_load_dwordx4 v9, s[8:11], s17 offen offset:1024 lds
    buffer_load_dwordx4 v10, s[8:11], s17 offen offset:2048 lds
    buffer_load_dwordx4 v11, s[8:11], s17 offen offset:3072 lds
    s_add_u32 m0, s19, 32768
    s_add_u32 s17, s17, 131072
    buffer_load_dwordx4 v8, s[8:11], s17 offen offset:0 lds
    buffer_load_dwordx4 v9, s[8:11], s17 offen offset:1024 lds
    buffer_load_dwordx4 v10, s[8:11], s17 offen offset:2048 lds
    buffer_load_dwordx4 v11, s[8:11], s17 offen offset:3072 lds
    s_add_u32 m0, s19, 65536
    s_add_u32 s17, s17, 131072
    buffer_load_dwordx4 v8, s[8:11], s17 offen offset:0 lds
    buffer_load_dwordx4 v9, s[8:11], s17 offen offset:1024 lds
    buffer_load_dwordx4 v10, s[8:11], s17 offen offset:2048 lds
    buffer_load_dwordx4 v11, s[8:11], s17 offen offset:3072 lds
    s_add_u32 m0, s19, 98304
    s_add_u32 s17, s17, 131072
    buffer_load_dwordx4 v8, s[8:11], s17 offen offset:0 lds
    buffer_load_dwordx4 v9, s[8:11], s17 offen offset:1024 lds
    buffer_load_dwordx4 v10, s[8:11], s17 offen offset:2048 lds
    buffer_load_dwordx4 v11, s[8:11], s17 offen offset:3072 lds
    v_lshrrev_b32 v20, 2, v1
    v_and_b32 v20, 7, v20
    v_lshrrev_b32 v21, 1, v20
    s_lshl_b32 s45, s44, 1
    v_xor_b32 v21, s45, v21
    v_lshlrev_b32 v21, 5, v21
    v_lshlrev_b32 v20, 7, v20
    v_lshrrev_b32 v22, 5, v1
    v_mul_u32_u24 v22, 4096, v22
    v_add_u32 v20, v20, v22
    v_and_b32 v22, 3, v1
    v_lshl_add_u32 v20, v22, 3, v20
    v_add_u32 v20, 16384, v20
    v_add_u32 v25, v20, v21
    v_xor_b32 v21, 32, v21
    v_add_u32 v26, v20, v21
    v_add_u32 v27, 65536, v24
    v_add_u32 v28, 65536, v25
    v_add_u32 v29, 65536, v26
    v_mov_b32 v32, 0
    v_mov_b32 v33, 0
    v_mov_b32 v34, 0
    v_mov_b32 v35, 0
    v_mov_b32 v36, 0
    v_mov_b32 v37, 0
    v_mov_b32 v38, 0
    v_mov_b32 v39, 0
    v_mov_b32 v40, 0
    v_mov_b32 v41, 0
    v_mov_b32 v42, 0
    v_mov_b32 v43, 0
    v_mov_b32 v44, 0
    v_mov_b32 v45, 0
    v_mov_b32 v46, 0
    v_mov_b32 v47, 0
    v_mov_b32 v48, 0
    v_mov_b32 v49, 0
    v_mov_b32 v50, 0
    v_mov_b32 v51, 0
    v_mov_b32 v52, 0
    v_mov_b32 v53, 0
    v_mov_b32 v54, 0
    v_mov_b32 v55, 0
    v_mov_b32 v56, 0
    v_mov_b32 v57, 0
    v_mov_b32 v58, 0
    v_mov_b32 v59, 0
    v_mov_b32 v60, 0
    v_mov_b32 v61, 0
    v_mov_b32 v62, 0
    v_mov_b32 v63, 0
    v_mov_b32 v64, 0
    v_mov_b32 v65, 0
    v_mov_b32 v66, 0
    v_mov_b32 v67, 0
    v_mov_b32 v68, 0
    v_mov_b32 v69, 0
    v_mov_b32 v70, 0
    v_mov_b32 v71, 0
    v_mov_b32 v72, 0
    v_mov_b32 v73, 0
    v_mov_b32 v74, 0
    v_mov_b32 v75, 0
    v_mov_b32 v76, 0
    v_mov_b32 v77, 0
    v_mov_b32 v78, 0
    v_mov_b32 v79, 0
    v_mov_b32 v80, 0
    v_mov_b32 v81, 0
    v_mov_b32 v82, 0
    v_mov_b32 v83, 0
    v_mov_b32 v84, 0
    v_mov_b32 v85, 0
    v_mov_b32 v86, 0
    v_mov_b32 v87, 0
    v_mov_b32 v88, 0
    v_mov_b32 v89, 0
    v_mov_b32 v90, 0
    v_mov_b32 v91, 0
    v_mov_b32 v92, 0
    v_mov_b32 v93, 0
    v_mov_b32 v94, 0
    v_mov_b32 v95, 0
    s_lshl_b32 s45, s40, 6
    s_lshl_b32 s46, s43, 5
    s_add_u32 s45, s45, s46
    v_add_u32 v17, s45, v3
    v_lshlrev_b32 v16, 11, v17
    s_lshl_b32 s45, s41, 8
    s_lshl_b32 s46, s44, 6
    s_add_u32 s45, s45, s46
    v_and_b32 v18, 1, v2
    v_lshl_add_u32 v16, v18, 5, v16
    v_lshrrev_b32 v18, 1, v2
    v_lshl_add_u32 v16, v18, 4, v16
    v_add_u32 v16, s45, v16
    s_lshl_b32 s45, s40, 5
    s_lshl_b32 s46, s41, 2
    s_add_u32 s45, s45, s46
    s_add_u32 s45, s45, s44
    s_lshl_b32 s45, s45, 12
    s_lshl_b32 s46, s43, 11
    s_add_u32 s50, s45, s46
    s_add_u32 s51, s50, 8192
    s_mov_b32 s49, 32768
    v_accvgpr_read_b32 v224, a184
    v_accvgpr_read_b32 v225, a185
    v_accvgpr_read_b32 v226, a186
    v_accvgpr_read_b32 v227, a187
    v_accvgpr_read_b32 v228, a188
    v_accvgpr_read_b32 v229, a189
    v_accvgpr_read_b32 v230, a190
    v_accvgpr_read_b32 v231, a191
    v_accvgpr_read_b32 v232, a192
    v_accvgpr_read_b32 v233, a193
    v_accvgpr_read_b32 v234, a194
    v_accvgpr_read_b32 v235, a195
    v_accvgpr_read_b32 v236, a196
    v_accvgpr_read_b32 v237, a197
    v_accvgpr_read_b32 v238, a198
    v_accvgpr_read_b32 v239, a199
    s_cmp_lg_u32 s42, 0
    s_cbranch_scc1 sequential_preLN__softmax_full_mha__glu_gated_glu__prompt_kernel_b9b
    s_lshr_b32 s45, s40, 2
    s_add_u32 s45, s45, 48
    s_lshl_b32 s45, s45, 8
    v_mov_b32 v30, s45
    s_mov_b64 exec, 1
    s_mov_b32 s45, 0x20000
sequential_preLN__softmax_full_mha__glu_gated_glu__prompt_kernel_poll10:
    buffer_load_dword v31, v30, s[84:87], 0 offen sc1
    s_sub_u32 s45, s45, 1
    s_cbranch_scc1 sequential_preLN__softmax_full_mha__glu_gated_glu__prompt_kernel_poll10x
    s_waitcnt vmcnt(0)
    v_cmp_gt_u32 vcc, 32, v31
    s_and_b64 vcc, vcc, exec
    s_cbranch_scc1 sequential_preLN__softmax_full_mha__glu_gated_glu__prompt_kernel_poll10
sequential_preLN__softmax_full_mha__glu_gated_glu__prompt_kernel_poll10x:
    s_mov_b64 exec, -1
sequential_preLN__softmax_full_mha__glu_gated_glu__prompt_kernel_b9b:
    s_barrier
    s_add_u32 m0, s18, 0
    s_add_u32 s16, s16, 8192
    buffer_load_dwordx4 v4, s[4:7], s16 offen offset:0 sc1 lds
    buffer_load_dwordx4 v4, s[4:7], s16 offen offset:1024 sc1 lds
    buffer_load_dwordx4 v4, s[4:7], s16 offen offset:2048 sc1 lds
    buffer_load_dwordx4 v4, s[4:7], s16 offen offset:3072 sc1 lds
    s_add_u32 m0, s18, 32768
    s_add_u32 s16, s16, 8192
    buffer_load_dwordx4 v4, s[4:7], s16 offen offset:0 sc1 lds
    buffer_load_dwordx4 v4, s[4:7], s16 offen offset:1024 sc1 lds
    buffer_load_dwordx4 v4, s[4:7], s16 offen offset:2048 sc1 lds
    buffer_load_dwordx4 v4, s[4:7], s16 offen offset:3072 sc1 lds
    s_add_u32 m0, s18, 65536
    s_add_u32 s16, s16, 8192
    buffer_load_dwordx4 v4, s[4:7], s16 offen offset:0 sc1 lds
    buffer_load_dwordx4 v4, s[4:7], s16 offen offset:1024 sc1 lds
    buffer_load_dwordx4 v4, s[4:7], s16 offen offset:2048 sc1 lds
    buffer_load_dwordx4 v4, s[4:7], s16 offen offset:3072 sc1 lds
    s_add_u32 m0, s18, 98304
    s_add_u32 s16, s16, 8192
    buffer_load_dwordx4 v4, s[4:7], s16 offen offset:0 sc1 lds
    buffer_load_dwordx4 v4, s[4:7], s16 offen offset:1024 sc1 lds
    buffer_load_dwordx4 v4, s[4:7], s16 offen offset:2048 sc1 lds
    buffer_load_dwordx4 v4, s[4:7], s16 offen offset:3072 sc1 lds
    s_waitcnt vmcnt(4)
    s_barrier
    ds_read_b128 v[96:99], v24 offset:0
    ds_read_b128 v[100:103], v24 offset:1024
    ds_read_b128 v[104:107], v24 offset:8192
    ds_read_b128 v[108:111], v24 offset:9216
    ds_read_b64_tr_b16 v[160:161], v25 offset:0
    ds_read_b64_tr_b16 v[162:163], v25 offset:2048
    ds_read_b64_tr_b16 v[164:165], v26 offset:0
    ds_read_b64_tr_b16 v[166:167], v26 offset:2048
    ds_read_b64_tr_b16 v[168:169], v25 offset:1024
    ds_read_b64_tr_b16 v[170:171], v25 offset:3072
    ds_read_b64_tr_b16 v[172:173], v26 offset:1024
    ds_read_b64_tr_b16 v[174:175], v26 offset:3072
    ds_read_b128 v[112:115], v24 offset:4096
    ds_read_b128 v[116:119], v24 offset:5120
    ds_read_b128 v[120:123], v24 offset:12288
    ds_read_b128 v[124:127], v24 offset:13312
    ds_read_b64_tr_b16 v[176:177], v25 offset:8192
    ds_read_b64_tr_b16 v[178:179], v25 offset:10240
    ds_read_b64_tr_b16 v[180:181], v26 offset:8192
    ds_read_b64_tr_b16 v[182:183], v26 offset:10240
    ds_read_b64_tr_b16 v[184:185], v25 offset:9216
    ds_read_b64_tr_b16 v[186:187], v25 offset:11264
    ds_read_b64_tr_b16 v[188:189], v26 offset:9216
    ds_read_b64_tr_b16 v[190:191], v26 offset:11264
    s_mov_b32 s20, 7
    s_waitcnt lgkmcnt(0)
sequential_preLN__softmax_full_mha__glu_gated_glu__prompt_kernel_p5loop:
    v_mfma_f32_16x16x32_bf16 v[32:35], v[160:163], v[96:99], v[32:35]
    s_waitcnt vmcnt(16)
    s_barrier
    v_mfma_f32_16x16x32_bf16 v[36:39], v[160:163], v[100:103], v[36:39]
    ds_read_b128 v[128:131], v24 offset:32768
    s_add_u32 m0, s18, 0
    v_mfma_f32_16x16x32_bf16 v[40:43], v[160:163], v[104:107], v[40:43]
    ds_read_b128 v[132:135], v24 offset:33792
    v_mfma_f32_16x16x32_bf16 v[44:47], v[160:163], v[108:111], v[44:47]
    ds_read_b128 v[136:139], v24 offset:40960
    s_add_u32 s16, s16, 8192
    v_mfma_f32_16x16x32_bf16 v[48:51], v[164:167], v[96:99], v[48:51]
    ds_read_b128 v[140:143], v24 offset:41984
    v_mfma_f32_16x16x32_bf16 v[52:55], v[164:167], v[100:103], v[52:55]
    ds_read_b64_tr_b16 v[192:193], v25 offset:32768
    buffer_load_dwordx4 v4, s[4:7], s16 offen offset:0 sc1 lds
    v_mfma_f32_16x16x32_bf16 v[56:59], v[164:167], v[104:107], v[56:59]
    ds_read_b64_tr_b16 v[194:195], v25 offset:34816
    v_mfma_f32_16x16x32_bf16 v[60:63], v[164:167], v[108:111], v[60:63]
    ds_read_b64_tr_b16 v[196:197], v26 offset:32768
    buffer_load_dwordx4 v4, s[4:7], s16 offen offset:1024 sc1 lds
    v_mfma_f32_16x16x32_bf16 v[64:67], v[168:171], v[96:99], v[64:67]
    ds_read_b64_tr_b16 v[198:199], v26 offset:34816
    v_mfma_f32_16x16x32_bf16 v[68:71], v[168:171], v[100:103], v[68:71]
    ds_read_b64_tr_b16 v[200:201], v25 offset:33792
    buffer_load_dwordx4 v4, s[4:7], s16 offen offset:2048 sc1 lds
    v_mfma_f32_16x16x32_bf16 v[72:75], v[168:171], v[104:107], v[72:75]
    ds_read_b64_tr_b16 v[202:203], v25 offset:35840
    v_mfma_f32_16x16x32_bf16 v[76:79], v[168:171], v[108:111], v[76:79]
    ds_read_b64_tr_b16 v[204:205], v26 offset:33792
    buffer_load_dwordx4 v4, s[4:7], s16 offen offset:3072 sc1 lds
    v_mfma_f32_16x16x32_bf16 v[80:83], v[172:175], v[96:99], v[80:83]
    ds_read_b64_tr_b16 v[206:207], v26 offset:35840
    v_mfma_f32_16x16x32_bf16 v[84:87], v[172:175], v[100:103], v[84:87]
    ds_read_b128 v[144:147], v24 offset:36864
    s_add_u32 m0, s19, 0
    v_mfma_f32_16x16x32_bf16 v[88:91], v[172:175], v[104:107], v[88:91]
    ds_read_b128 v[148:151], v24 offset:37888
    v_mfma_f32_16x16x32_bf16 v[92:95], v[172:175], v[108:111], v[92:95]
    ds_read_b128 v[152:155], v24 offset:45056
    s_add_u32 s17, s17, 131072
    v_mfma_f32_16x16x32_bf16 v[32:35], v[176:179], v[112:115], v[32:35]
    ds_read_b128 v[156:159], v24 offset:46080
    v_mfma_f32_16x16x32_bf16 v[36:39], v[176:179], v[116:119], v[36:39]
    ds_read_b64_tr_b16 v[208:209], v25 offset:40960
    buffer_load_dwordx4 v8, s[8:11], s17 offen offset:0 lds
    v_mfma_f32_16x16x32_bf16 v[40:43], v[176:179], v[120:123], v[40:43]
    ds_read_b64_tr_b16 v[210:211], v25 offset:43008
    v_mfma_f32_16x16x32_bf16 v[44:47], v[176:179], v[124:127], v[44:47]
    ds_read_b64_tr_b16 v[212:213], v26 offset:40960
    buffer_load_dwordx4 v9, s[8:11], s17 offen offset:1024 lds
    v_mfma_f32_16x16x32_bf16 v[48:51], v[180:183], v[112:115], v[48:51]
    ds_read_b64_tr_b16 v[214:215], v26 offset:43008
    v_mfma_f32_16x16x32_bf16 v[52:55], v[180:183], v[116:119], v[52:55]
    ds_read_b64_tr_b16 v[216:217], v25 offset:41984
    buffer_load_dwordx4 v10, s[8:11], s17 offen offset:2048 lds
    v_mfma_f32_16x16x32_bf16 v[56:59], v[180:183], v[120:123], v[56:59]
    ds_read_b64_tr_b16 v[218:219], v25 offset:44032
    v_mfma_f32_16x16x32_bf16 v[60:63], v[180:183], v[124:127], v[60:63]
    ds_read_b64_tr_b16 v[220:221], v26 offset:41984
    buffer_load_dwordx4 v11, s[8:11], s17 offen offset:3072 lds
    v_mfma_f32_16x16x32_bf16 v[64:67], v[184:187], v[112:115], v[64:67]
    ds_read_b64_tr_b16 v[222:223], v26 offset:44032
    v_mfma_f32_16x16x32_bf16 v[68:71], v[184:187], v[116:119], v[68:71]
    v_mfma_f32_16x16x32_bf16 v[72:75], v[184:187], v[120:123], v[72:75]
    v_mfma_f32_16x16x32_bf16 v[76:79], v[184:187], v[124:127], v[76:79]
    v_mfma_f32_16x16x32_bf16 v[80:83], v[188:191], v[112:115], v[80:83]
    v_mfma_f32_16x16x32_bf16 v[84:87], v[188:191], v[116:119], v[84:87]
    v_mfma_f32_16x16x32_bf16 v[88:91], v[188:191], v[120:123], v[88:91]
    v_mfma_f32_16x16x32_bf16 v[92:95], v[188:191], v[124:127], v[92:95]
    s_waitcnt lgkmcnt(0)
    v_mfma_f32_16x16x32_bf16 v[32:35], v[192:195], v[128:131], v[32:35]
    s_waitcnt vmcnt(16)
    s_barrier
    v_mfma_f32_16x16x32_bf16 v[36:39], v[192:195], v[132:135], v[36:39]
    ds_read_b128 v[96:99], v27 offset:0
    s_add_u32 m0, s18, 32768
    v_mfma_f32_16x16x32_bf16 v[40:43], v[192:195], v[136:139], v[40:43]
    ds_read_b128 v[100:103], v27 offset:1024
    v_mfma_f32_16x16x32_bf16 v[44:47], v[192:195], v[140:143], v[44:47]
    ds_read_b128 v[104:107], v27 offset:8192
    s_add_u32 s16, s16, 8192
    v_mfma_f32_16x16x32_bf16 v[48:51], v[196:199], v[128:131], v[48:51]
    ds_read_b128 v[108:111], v27 offset:9216
    v_mfma_f32_16x16x32_bf16 v[52:55], v[196:199], v[132:135], v[52:55]
    ds_read_b64_tr_b16 v[160:161], v28 offset:0
    buffer_load_dwordx4 v4, s[4:7], s16 offen offset:0 sc1 lds
    v_mfma_f32_16x16x32_bf16 v[56:59], v[196:199], v[136:139], v[56:59]
    ds_read_b64_tr_b16 v[162:163], v28 offset:2048
    v_mfma_f32_16x16x32_bf16 v[60:63], v[196:199], v[140:143], v[60:63]
    ds_read_b64_tr_b16 v[164:165], v29 offset:0
    buffer_load_dwordx4 v4, s[4:7], s16 offen offset:1024 sc1 lds
    v_mfma_f32_16x16x32_bf16 v[64:67], v[200:203], v[128:131], v[64:67]
    ds_read_b64_tr_b16 v[166:167], v29 offset:2048
    v_mfma_f32_16x16x32_bf16 v[68:71], v[200:203], v[132:135], v[68:71]
    ds_read_b64_tr_b16 v[168:169], v28 offset:1024
    buffer_load_dwordx4 v4, s[4:7], s16 offen offset:2048 sc1 lds
    v_mfma_f32_16x16x32_bf16 v[72:75], v[200:203], v[136:139], v[72:75]
    ds_read_b64_tr_b16 v[170:171], v28 offset:3072
    v_mfma_f32_16x16x32_bf16 v[76:79], v[200:203], v[140:143], v[76:79]
    ds_read_b64_tr_b16 v[172:173], v29 offset:1024
    buffer_load_dwordx4 v4, s[4:7], s16 offen offset:3072 sc1 lds
    v_mfma_f32_16x16x32_bf16 v[80:83], v[204:207], v[128:131], v[80:83]
    ds_read_b64_tr_b16 v[174:175], v29 offset:3072
    v_mfma_f32_16x16x32_bf16 v[84:87], v[204:207], v[132:135], v[84:87]
    ds_read_b128 v[112:115], v27 offset:4096
    s_add_u32 m0, s19, 32768
    v_mfma_f32_16x16x32_bf16 v[88:91], v[204:207], v[136:139], v[88:91]
    ds_read_b128 v[116:119], v27 offset:5120
    v_mfma_f32_16x16x32_bf16 v[92:95], v[204:207], v[140:143], v[92:95]
    ds_read_b128 v[120:123], v27 offset:12288
    s_add_u32 s17, s17, 131072
    v_mfma_f32_16x16x32_bf16 v[32:35], v[208:211], v[144:147], v[32:35]
    ds_read_b128 v[124:127], v27 offset:13312
    v_mfma_f32_16x16x32_bf16 v[36:39], v[208:211], v[148:151], v[36:39]
    ds_read_b64_tr_b16 v[176:177], v28 offset:8192
    buffer_load_dwordx4 v8, s[8:11], s17 offen offset:0 lds
    v_mfma_f32_16x16x32_bf16 v[40:43], v[208:211], v[152:155], v[40:43]
    ds_read_b64_tr_b16 v[178:179], v28 offset:10240
    v_mfma_f32_16x16x32_bf16 v[44:47], v[208:211], v[156:159], v[44:47]
    ds_read_b64_tr_b16 v[180:181], v29 offset:8192
    buffer_load_dwordx4 v9, s[8:11], s17 offen offset:1024 lds
    v_mfma_f32_16x16x32_bf16 v[48:51], v[212:215], v[144:147], v[48:51]
    ds_read_b64_tr_b16 v[182:183], v29 offset:10240
    v_mfma_f32_16x16x32_bf16 v[52:55], v[212:215], v[148:151], v[52:55]
    ds_read_b64_tr_b16 v[184:185], v28 offset:9216
    buffer_load_dwordx4 v10, s[8:11], s17 offen offset:2048 lds
    v_mfma_f32_16x16x32_bf16 v[56:59], v[212:215], v[152:155], v[56:59]
    ds_read_b64_tr_b16 v[186:187], v28 offset:11264
    v_mfma_f32_16x16x32_bf16 v[60:63], v[212:215], v[156:159], v[60:63]
    ds_read_b64_tr_b16 v[188:189], v29 offset:9216
    buffer_load_dwordx4 v11, s[8:11], s17 offen offset:3072 lds
    v_mfma_f32_16x16x32_bf16 v[64:67], v[216:219], v[144:147], v[64:67]
    ds_read_b64_tr_b16 v[190:191], v29 offset:11264
    v_mfma_f32_16x16x32_bf16 v[68:71], v[216:219], v[148:151], v[68:71]
    v_mfma_f32_16x16x32_bf16 v[72:75], v[216:219], v[152:155], v[72:75]
    v_mfma_f32_16x16x32_bf16 v[76:79], v[216:219], v[156:159], v[76:79]
    v_mfma_f32_16x16x32_bf16 v[80:83], v[220:223], v[144:147], v[80:83]
    v_mfma_f32_16x16x32_bf16 v[84:87], v[220:223], v[148:151], v[84:87]
    v_mfma_f32_16x16x32_bf16 v[88:91], v[220:223], v[152:155], v[88:91]
    v_mfma_f32_16x16x32_bf16 v[92:95], v[220:223], v[156:159], v[92:95]
    s_waitcnt lgkmcnt(0)
    v_mfma_f32_16x16x32_bf16 v[32:35], v[160:163], v[96:99], v[32:35]
    s_waitcnt vmcnt(16)
    s_barrier
    v_mfma_f32_16x16x32_bf16 v[36:39], v[160:163], v[100:103], v[36:39]
    ds_read_b128 v[128:131], v27 offset:32768
    s_add_u32 m0, s18, 65536
    v_mfma_f32_16x16x32_bf16 v[40:43], v[160:163], v[104:107], v[40:43]
    ds_read_b128 v[132:135], v27 offset:33792
    v_mfma_f32_16x16x32_bf16 v[44:47], v[160:163], v[108:111], v[44:47]
    ds_read_b128 v[136:139], v27 offset:40960
    s_add_u32 s16, s16, 8192
    v_mfma_f32_16x16x32_bf16 v[48:51], v[164:167], v[96:99], v[48:51]
    ds_read_b128 v[140:143], v27 offset:41984
    v_mfma_f32_16x16x32_bf16 v[52:55], v[164:167], v[100:103], v[52:55]
    ds_read_b64_tr_b16 v[192:193], v28 offset:32768
    buffer_load_dwordx4 v4, s[4:7], s16 offen offset:0 sc1 lds
    v_mfma_f32_16x16x32_bf16 v[56:59], v[164:167], v[104:107], v[56:59]
    ds_read_b64_tr_b16 v[194:195], v28 offset:34816
    v_mfma_f32_16x16x32_bf16 v[60:63], v[164:167], v[108:111], v[60:63]
    ds_read_b64_tr_b16 v[196:197], v29 offset:32768
    buffer_load_dwordx4 v4, s[4:7], s16 offen offset:1024 sc1 lds
    v_mfma_f32_16x16x32_bf16 v[64:67], v[168:171], v[96:99], v[64:67]
    ds_read_b64_tr_b16 v[198:199], v29 offset:34816
    v_mfma_f32_16x16x32_bf16 v[68:71], v[168:171], v[100:103], v[68:71]
    ds_read_b64_tr_b16 v[200:201], v28 offset:33792
    buffer_load_dwordx4 v4, s[4:7], s16 offen offset:2048 sc1 lds
    v_mfma_f32_16x16x32_bf16 v[72:75], v[168:171], v[104:107], v[72:75]
    ds_read_b64_tr_b16 v[202:203], v28 offset:35840
    v_mfma_f32_16x16x32_bf16 v[76:79], v[168:171], v[108:111], v[76:79]
    ds_read_b64_tr_b16 v[204:205], v29 offset:33792
    buffer_load_dwordx4 v4, s[4:7], s16 offen offset:3072 sc1 lds
    v_mfma_f32_16x16x32_bf16 v[80:83], v[172:175], v[96:99], v[80:83]
    ds_read_b64_tr_b16 v[206:207], v29 offset:35840
    v_mfma_f32_16x16x32_bf16 v[84:87], v[172:175], v[100:103], v[84:87]
    ds_read_b128 v[144:147], v27 offset:36864
    s_add_u32 m0, s19, 65536
    v_mfma_f32_16x16x32_bf16 v[88:91], v[172:175], v[104:107], v[88:91]
    ds_read_b128 v[148:151], v27 offset:37888
    v_mfma_f32_16x16x32_bf16 v[92:95], v[172:175], v[108:111], v[92:95]
    ds_read_b128 v[152:155], v27 offset:45056
    s_add_u32 s17, s17, 131072
    v_mfma_f32_16x16x32_bf16 v[32:35], v[176:179], v[112:115], v[32:35]
    ds_read_b128 v[156:159], v27 offset:46080
    v_mfma_f32_16x16x32_bf16 v[36:39], v[176:179], v[116:119], v[36:39]
    ds_read_b64_tr_b16 v[208:209], v28 offset:40960
    buffer_load_dwordx4 v8, s[8:11], s17 offen offset:0 lds
    v_mfma_f32_16x16x32_bf16 v[40:43], v[176:179], v[120:123], v[40:43]
    ds_read_b64_tr_b16 v[210:211], v28 offset:43008
    v_mfma_f32_16x16x32_bf16 v[44:47], v[176:179], v[124:127], v[44:47]
    ds_read_b64_tr_b16 v[212:213], v29 offset:40960
    buffer_load_dwordx4 v9, s[8:11], s17 offen offset:1024 lds
    v_mfma_f32_16x16x32_bf16 v[48:51], v[180:183], v[112:115], v[48:51]
    ds_read_b64_tr_b16 v[214:215], v29 offset:43008
    v_mfma_f32_16x16x32_bf16 v[52:55], v[180:183], v[116:119], v[52:55]
    ds_read_b64_tr_b16 v[216:217], v28 offset:41984
    buffer_load_dwordx4 v10, s[8:11], s17 offen offset:2048 lds
    v_mfma_f32_16x16x32_bf16 v[56:59], v[180:183], v[120:123], v[56:59]
    ds_read_b64_tr_b16 v[218:219], v28 offset:44032
    v_mfma_f32_16x16x32_bf16 v[60:63], v[180:183], v[124:127], v[60:63]
    ds_read_b64_tr_b16 v[220:221], v29 offset:41984
    buffer_load_dwordx4 v11, s[8:11], s17 offen offset:3072 lds
    v_mfma_f32_16x16x32_bf16 v[64:67], v[184:187], v[112:115], v[64:67]
    ds_read_b64_tr_b16 v[222:223], v29 offset:44032
    v_mfma_f32_16x16x32_bf16 v[68:71], v[184:187], v[116:119], v[68:71]
    v_mfma_f32_16x16x32_bf16 v[72:75], v[184:187], v[120:123], v[72:75]
    v_mfma_f32_16x16x32_bf16 v[76:79], v[184:187], v[124:127], v[76:79]
    v_mfma_f32_16x16x32_bf16 v[80:83], v[188:191], v[112:115], v[80:83]
    v_mfma_f32_16x16x32_bf16 v[84:87], v[188:191], v[116:119], v[84:87]
    v_mfma_f32_16x16x32_bf16 v[88:91], v[188:191], v[120:123], v[88:91]
    v_mfma_f32_16x16x32_bf16 v[92:95], v[188:191], v[124:127], v[92:95]
    s_waitcnt lgkmcnt(0)
    v_mfma_f32_16x16x32_bf16 v[32:35], v[192:195], v[128:131], v[32:35]
    s_waitcnt vmcnt(16)
    s_barrier
    v_mfma_f32_16x16x32_bf16 v[36:39], v[192:195], v[132:135], v[36:39]
    ds_read_b128 v[96:99], v24 offset:0
    s_add_u32 m0, s18, 98304
    v_mfma_f32_16x16x32_bf16 v[40:43], v[192:195], v[136:139], v[40:43]
    ds_read_b128 v[100:103], v24 offset:1024
    v_mfma_f32_16x16x32_bf16 v[44:47], v[192:195], v[140:143], v[44:47]
    ds_read_b128 v[104:107], v24 offset:8192
    s_add_u32 s16, s16, 8192
    v_mfma_f32_16x16x32_bf16 v[48:51], v[196:199], v[128:131], v[48:51]
    ds_read_b128 v[108:111], v24 offset:9216
    v_mfma_f32_16x16x32_bf16 v[52:55], v[196:199], v[132:135], v[52:55]
    ds_read_b64_tr_b16 v[160:161], v25 offset:0
    buffer_load_dwordx4 v4, s[4:7], s16 offen offset:0 sc1 lds
    v_mfma_f32_16x16x32_bf16 v[56:59], v[196:199], v[136:139], v[56:59]
    ds_read_b64_tr_b16 v[162:163], v25 offset:2048
    v_mfma_f32_16x16x32_bf16 v[60:63], v[196:199], v[140:143], v[60:63]
    ds_read_b64_tr_b16 v[164:165], v26 offset:0
    buffer_load_dwordx4 v4, s[4:7], s16 offen offset:1024 sc1 lds
    v_mfma_f32_16x16x32_bf16 v[64:67], v[200:203], v[128:131], v[64:67]
    ds_read_b64_tr_b16 v[166:167], v26 offset:2048
    v_mfma_f32_16x16x32_bf16 v[68:71], v[200:203], v[132:135], v[68:71]
    ds_read_b64_tr_b16 v[168:169], v25 offset:1024
    buffer_load_dwordx4 v4, s[4:7], s16 offen offset:2048 sc1 lds
    v_mfma_f32_16x16x32_bf16 v[72:75], v[200:203], v[136:139], v[72:75]
    ds_read_b64_tr_b16 v[170:171], v25 offset:3072
    v_mfma_f32_16x16x32_bf16 v[76:79], v[200:203], v[140:143], v[76:79]
    ds_read_b64_tr_b16 v[172:173], v26 offset:1024
    buffer_load_dwordx4 v4, s[4:7], s16 offen offset:3072 sc1 lds
    v_mfma_f32_16x16x32_bf16 v[80:83], v[204:207], v[128:131], v[80:83]
    ds_read_b64_tr_b16 v[174:175], v26 offset:3072
    v_mfma_f32_16x16x32_bf16 v[84:87], v[204:207], v[132:135], v[84:87]
    ds_read_b128 v[112:115], v24 offset:4096
    s_add_u32 m0, s19, 98304
    v_mfma_f32_16x16x32_bf16 v[88:91], v[204:207], v[136:139], v[88:91]
    ds_read_b128 v[116:119], v24 offset:5120
    v_mfma_f32_16x16x32_bf16 v[92:95], v[204:207], v[140:143], v[92:95]
    ds_read_b128 v[120:123], v24 offset:12288
    s_add_u32 s17, s17, 131072
    v_mfma_f32_16x16x32_bf16 v[32:35], v[208:211], v[144:147], v[32:35]
    ds_read_b128 v[124:127], v24 offset:13312
    v_mfma_f32_16x16x32_bf16 v[36:39], v[208:211], v[148:151], v[36:39]
    ds_read_b64_tr_b16 v[176:177], v25 offset:8192
    buffer_load_dwordx4 v8, s[8:11], s17 offen offset:0 lds
    v_mfma_f32_16x16x32_bf16 v[40:43], v[208:211], v[152:155], v[40:43]
    ds_read_b64_tr_b16 v[178:179], v25 offset:10240
    v_mfma_f32_16x16x32_bf16 v[44:47], v[208:211], v[156:159], v[44:47]
    ds_read_b64_tr_b16 v[180:181], v26 offset:8192
    buffer_load_dwordx4 v9, s[8:11], s17 offen offset:1024 lds
    v_mfma_f32_16x16x32_bf16 v[48:51], v[212:215], v[144:147], v[48:51]
    ds_read_b64_tr_b16 v[182:183], v26 offset:10240
    v_mfma_f32_16x16x32_bf16 v[52:55], v[212:215], v[148:151], v[52:55]
    ds_read_b64_tr_b16 v[184:185], v25 offset:9216
    buffer_load_dwordx4 v10, s[8:11], s17 offen offset:2048 lds
    v_mfma_f32_16x16x32_bf16 v[56:59], v[212:215], v[152:155], v[56:59]
    ds_read_b64_tr_b16 v[186:187], v25 offset:11264
    v_mfma_f32_16x16x32_bf16 v[60:63], v[212:215], v[156:159], v[60:63]
    ds_read_b64_tr_b16 v[188:189], v26 offset:9216
    buffer_load_dwordx4 v11, s[8:11], s17 offen offset:3072 lds
    v_mfma_f32_16x16x32_bf16 v[64:67], v[216:219], v[144:147], v[64:67]
    ds_read_b64_tr_b16 v[190:191], v26 offset:11264
    v_mfma_f32_16x16x32_bf16 v[68:71], v[216:219], v[148:151], v[68:71]
    v_mfma_f32_16x16x32_bf16 v[72:75], v[216:219], v[152:155], v[72:75]
    v_mfma_f32_16x16x32_bf16 v[76:79], v[216:219], v[156:159], v[76:79]
    v_mfma_f32_16x16x32_bf16 v[80:83], v[220:223], v[144:147], v[80:83]
    v_mfma_f32_16x16x32_bf16 v[84:87], v[220:223], v[148:151], v[84:87]
    s_sub_u32 s20, s20, 1
    v_mfma_f32_16x16x32_bf16 v[88:91], v[220:223], v[152:155], v[88:91]
    s_cmp_lg_u32 s20, 0
    v_mfma_f32_16x16x32_bf16 v[92:95], v[220:223], v[156:159], v[92:95]
    s_waitcnt lgkmcnt(0)
    s_cbranch_scc1 sequential_preLN__softmax_full_mha__glu_gated_glu__prompt_kernel_p5loop
    s_waitcnt vmcnt(0)
    s_barrier
    s_nop 5
    s_lshl_b32 s45, s2, 2
    s_add_u32 s45, s45, s42
    s_lshl_b32 s46, s45, 13
    s_add_u32 s47, s46, 4096
    s_lshl_b32 s45, s45, 6
    s_add_u32 s45, s45, 32768
    v_cvt_pk_bf16_f32 v144, v40, v41
    v_cvt_pk_bf16_f32 v145, v42, v43
    v_cvt_pk_bf16_f32 v146, v56, v57
    v_cvt_pk_bf16_f32 v147, v58, v59
    buffer_store_dwordx4 v[144:147], v4, s[56:59], s46 offen offset:0 sc1
    v_cvt_pk_bf16_f32 v148, v44, v45
    v_cvt_pk_bf16_f32 v149, v46, v47
    v_cvt_pk_bf16_f32 v150, v60, v61
    v_cvt_pk_bf16_f32 v151, v62, v63
    buffer_store_dwordx4 v[148:151], v4, s[56:59], s46 offen offset:1024 sc1
    v_cvt_pk_bf16_f32 v152, v72, v73
    v_cvt_pk_bf16_f32 v153, v74, v75
    v_cvt_pk_bf16_f32 v154, v88, v89
    v_cvt_pk_bf16_f32 v155, v90, v91
    buffer_store_dwordx4 v[152:155], v4, s[56:59], s46 offen offset:2048 sc1
    v_cvt_pk_bf16_f32 v156, v76, v77
    v_cvt_pk_bf16_f32 v157, v78, v79
    v_cvt_pk_bf16_f32 v158, v92, v93
    v_cvt_pk_bf16_f32 v159, v94, v95
    buffer_store_dwordx4 v[156:159], v4, s[56:59], s46 offen offset:3072 sc1
    v_mov_b32 v29, s45
    v_xor_b32 v30, 2048, v29
    v_mov_b32 v31, 1
    s_xor_b32 s46, s46, 262144
    s_xor_b32 s47, s47, 262144
    v_lshlrev_b32 v18, 16, v224
    v_and_b32 v19, 0xffff0000, v224
    v_pk_add_f32 v[32:33], v[32:33], v[18:19] op_sel:[0,0] op_sel_hi:[1,1]
    v_lshlrev_b32 v18, 16, v225
    v_and_b32 v19, 0xffff0000, v225
    v_pk_add_f32 v[34:35], v[34:35], v[18:19] op_sel:[0,0] op_sel_hi:[1,1]
    v_lshlrev_b32 v18, 16, v226
    v_and_b32 v19, 0xffff0000, v226
    v_pk_add_f32 v[48:49], v[48:49], v[18:19] op_sel:[0,0] op_sel_hi:[1,1]
    v_lshlrev_b32 v18, 16, v227
    v_and_b32 v19, 0xffff0000, v227
    v_pk_add_f32 v[50:51], v[50:51], v[18:19] op_sel:[0,0] op_sel_hi:[1,1]
    v_lshlrev_b32 v18, 16, v228
    v_and_b32 v19, 0xffff0000, v228
    v_pk_add_f32 v[36:37], v[36:37], v[18:19] op_sel:[0,0] op_sel_hi:[1,1]
    v_lshlrev_b32 v18, 16, v229
    v_and_b32 v19, 0xffff0000, v229
    v_pk_add_f32 v[38:39], v[38:39], v[18:19] op_sel:[0,0] op_sel_hi:[1,1]
    v_lshlrev_b32 v18, 16, v230
    v_and_b32 v19, 0xffff0000, v230
    v_pk_add_f32 v[52:53], v[52:53], v[18:19] op_sel:[0,0] op_sel_hi:[1,1]
    v_lshlrev_b32 v18, 16, v231
    v_and_b32 v19, 0xffff0000, v231
    v_pk_add_f32 v[54:55], v[54:55], v[18:19] op_sel:[0,0] op_sel_hi:[1,1]
    v_lshlrev_b32 v18, 16, v232
    v_and_b32 v19, 0xffff0000, v232
    v_pk_add_f32 v[64:65], v[64:65], v[18:19] op_sel:[0,0] op_sel_hi:[1,1]
    v_lshlrev_b32 v18, 16, v233
    v_and_b32 v19, 0xffff0000, v233
    v_pk_add_f32 v[66:67], v[66:67], v[18:19] op_sel:[0,0] op_sel_hi:[1,1]
    v_lshlrev_b32 v18, 16, v234
    v_and_b32 v19, 0xffff0000, v234
    v_pk_add_f32 v[80:81], v[80:81], v[18:19] op_sel:[0,0] op_sel_hi:[1,1]
    v_lshlrev_b32 v18, 16, v235
    v_and_b32 v19, 0xffff0000, v235
    v_pk_add_f32 v[82:83], v[82:83], v[18:19] op_sel:[0,0] op_sel_hi:[1,1]
    v_lshlrev_b32 v18, 16, v236
    v_and_b32 v19, 0xffff0000, v236
    v_pk_add_f32 v[68:69], v[68:69], v[18:19] op_sel:[0,0] op_sel_hi:[1,1]
    v_lshlrev_b32 v18, 16, v237
    v_and_b32 v19, 0xffff0000, v237
    v_pk_add_f32 v[70:71], v[70:71], v[18:19] op_sel:[0,0] op_sel_hi:[1,1]
    v_lshlrev_b32 v18, 16, v238
    v_and_b32 v19, 0xffff0000, v238
    v_pk_add_f32 v[84:85], v[84:85], v[18:19] op_sel:[0,0] op_sel_hi:[1,1]
    v_lshlrev_b32 v18, 16, v239
    v_and_b32 v19, 0xffff0000, v239
    v_pk_add_f32 v[86:87], v[86:87], v[18:19] op_sel:[0,0] op_sel_hi:[1,1]
    s_mov_b64 exec, 1
    s_waitcnt vmcnt(0)
    buffer_store_dword v31, v29, s[84:87], 0 offen sc1
    s_nop 0
    s_mov_b64 exec, 1
    s_mov_b32 s45, 0x20000
sequential_preLN__softmax_full_mha__glu_gated_glu__prompt_kernel_poll11:
    buffer_load_dword v31, v30, s[84:87], 0 offen sc1
    s_sub_u32 s45, s45, 1
    s_cbranch_scc1 sequential_preLN__softmax_full_mha__glu_gated_glu__prompt_kernel_poll11x
    s_waitcnt vmcnt(0)
    v_cmp_gt_u32 vcc, 1, v31
    s_and_b64 vcc, vcc, exec
    s_cbranch_scc1 sequential_preLN__softmax_full_mha__glu_gated_glu__prompt_kernel_poll11
sequential_preLN__softmax_full_mha__glu_gated_glu__prompt_kernel_poll11x:
    s_mov_b64 exec, -1
    buffer_load_dwordx4 v[96:99], v4, s[56:59], s46 offen offset:0 sc1
    buffer_load_dwordx4 v[100:103], v4, s[56:59], s46 offen offset:1024 sc1
    buffer_load_dwordx4 v[104:107], v4, s[56:59], s46 offen offset:2048 sc1
    buffer_load_dwordx4 v[108:111], v4, s[56:59], s46 offen offset:3072 sc1
    s_waitcnt vmcnt(3)
    v_lshlrev_b32 v18, 16, v96
    v_and_b32 v19, 0xffff0000, v96
    v_pk_add_f32 v[32:33], v[32:33], v[18:19] op_sel:[0,0] op_sel_hi:[1,1]
    v_lshlrev_b32 v18, 16, v97
    v_and_b32 v19, 0xffff0000, v97
    v_pk_add_f32 v[34:35], v[34:35], v[18:19] op_sel:[0,0] op_sel_hi:[1,1]
    v_lshlrev_b32 v18, 16, v98
    v_and_b32 v19, 0xffff0000, v98
    v_pk_add_f32 v[48:49], v[48:49], v[18:19] op_sel:[0,0] op_sel_hi:[1,1]
    v_lshlrev_b32 v18, 16, v99
    v_and_b32 v19, 0xffff0000, v99
    v_pk_add_f32 v[50:51], v[50:51], v[18:19] op_sel:[0,0] op_sel_hi:[1,1]
    v_cvt_pk_bf16_f32 v128, v32, v33
    v_cvt_pk_bf16_f32 v129, v34, v35
    v_cvt_pk_bf16_f32 v130, v48, v49
    v_cvt_pk_bf16_f32 v131, v50, v51
    s_nop 1
    v_permlane16_swap_b32 v128, v130
    v_permlane16_swap_b32 v129, v131
    buffer_store_dwordx4 v[128:131], v16, s[52:55], 0 offen offset:0
    s_waitcnt vmcnt(3)
    v_lshlrev_b32 v18, 16, v100
    v_and_b32 v19, 0xffff0000, v100
    v_pk_add_f32 v[36:37], v[36:37], v[18:19] op_sel:[0,0] op_sel_hi:[1,1]
    v_lshlrev_b32 v18, 16, v101
    v_and_b32 v19, 0xffff0000, v101
    v_pk_add_f32 v[38:39], v[38:39], v[18:19] op_sel:[0,0] op_sel_hi:[1,1]
    v_lshlrev_b32 v18, 16, v102
    v_and_b32 v19, 0xffff0000, v102
    v_pk_add_f32 v[52:53], v[52:53], v[18:19] op_sel:[0,0] op_sel_hi:[1,1]
    v_lshlrev_b32 v18, 16, v103
    v_and_b32 v19, 0xffff0000, v103
    v_pk_add_f32 v[54:55], v[54:55], v[18:19] op_sel:[0,0] op_sel_hi:[1,1]
    v_cvt_pk_bf16_f32 v132, v36, v37
    v_cvt_pk_bf16_f32 v133, v38, v39
    v_cvt_pk_bf16_f32 v134, v52, v53
    v_cvt_pk_bf16_f32 v135, v54, v55
    s_nop 1
    v_permlane16_swap_b32 v132, v134
    v_permlane16_swap_b32 v133, v135
    buffer_store_dwordx4 v[132:135], v16, s[52:55], s49 offen offset:0
    s_waitcnt vmcnt(3)
    v_lshlrev_b32 v18, 16, v104
    v_and_b32 v19, 0xffff0000, v104
    v_pk_add_f32 v[64:65], v[64:65], v[18:19] op_sel:[0,0] op_sel_hi:[1,1]
    v_lshlrev_b32 v18, 16, v105
    v_and_b32 v19, 0xffff0000, v105
    v_pk_add_f32 v[66:67], v[66:67], v[18:19] op_sel:[0,0] op_sel_hi:[1,1]
    v_lshlrev_b32 v18, 16, v106
    v_and_b32 v19, 0xffff0000, v106
    v_pk_add_f32 v[80:81], v[80:81], v[18:19] op_sel:[0,0] op_sel_hi:[1,1]
    v_lshlrev_b32 v18, 16, v107
    v_and_b32 v19, 0xffff0000, v107
    v_pk_add_f32 v[82:83], v[82:83], v[18:19] op_sel:[0,0] op_sel_hi:[1,1]
    v_cvt_pk_bf16_f32 v136, v64, v65
    v_cvt_pk_bf16_f32 v137, v66, v67
    v_cvt_pk_bf16_f32 v138, v80, v81
    v_cvt_pk_bf16_f32 v139, v82, v83
    s_nop 1
    v_permlane16_swap_b32 v136, v138
    v_permlane16_swap_b32 v137, v139
    buffer_store_dwordx4 v[136:139], v16, s[52:55], 0 offen offset:128
    s_waitcnt vmcnt(3)
    v_lshlrev_b32 v18, 16, v108
    v_and_b32 v19, 0xffff0000, v108
    v_pk_add_f32 v[68:69], v[68:69], v[18:19] op_sel:[0,0] op_sel_hi:[1,1]
    v_lshlrev_b32 v18, 16, v109
    v_and_b32 v19, 0xffff0000, v109
    v_pk_add_f32 v[70:71], v[70:71], v[18:19] op_sel:[0,0] op_sel_hi:[1,1]
    v_lshlrev_b32 v18, 16, v110
    v_and_b32 v19, 0xffff0000, v110
    v_pk_add_f32 v[84:85], v[84:85], v[18:19] op_sel:[0,0] op_sel_hi:[1,1]
    v_lshlrev_b32 v18, 16, v111
    v_and_b32 v19, 0xffff0000, v111
    v_pk_add_f32 v[86:87], v[86:87], v[18:19] op_sel:[0,0] op_sel_hi:[1,1]
    v_cvt_pk_bf16_f32 v140, v68, v69
    v_cvt_pk_bf16_f32 v141, v70, v71
    v_cvt_pk_bf16_f32 v142, v84, v85
    v_cvt_pk_bf16_f32 v143, v86, v87
    s_nop 1
    v_permlane16_swap_b32 v140, v142
    v_permlane16_swap_b32 v141, v143
    buffer_store_dwordx4 v[140:143], v16, s[52:55], s49 offen offset:128
sequential_preLN__softmax_full_mha__glu_gated_glu__prompt_kernel_end:
    s_endpgm
.section .rodata,"a"
.p2align 6
.amdhsa_kernel sequential_preLN__softmax_full_mha__glu_gated_glu__prompt_kernel
  .amdhsa_next_free_vgpr 456
  .amdhsa_next_free_sgpr 102
  .amdhsa_accum_offset 256
  .amdhsa_group_segment_fixed_size 0
  .amdhsa_kernarg_size 80
  .amdhsa_user_sgpr_count 2
  .amdhsa_user_sgpr_kernarg_segment_ptr 1
  .amdhsa_system_sgpr_workgroup_id_x 1
.end_amdhsa_kernel
```
